```python
import torch

def _softmax(x, axis=-1):
    return torch.softmax(x, dim=axis)
def _gelu(x):
    return torch.nn.functional.gelu(x, approximate="tanh")
def _silu(x):
    return torch.nn.functional.silu(x)
def _sigmoid(x):
    return torch.sigmoid(x)
def _layernorm(x, axis=-1, eps=1e-5):
    m = x.mean(dim=axis, keepdim=True)
    v = x.var(dim=axis, keepdim=True, unbiased=False)
    return (x - m) / torch.sqrt(v + eps)
def _scatter_add(tgt, idx, src, axis=0):
    return tgt.clone().index_add_(axis, idx, src)
def _segment_sum(src, seg, n):
    out = torch.zeros((n,) + src.shape[1:], dtype=src.dtype)
    return out.index_add_(0, seg, src)
def _pad(x, pw):
    flat = tuple(v for pair in reversed(pw) for v in pair)
    return torch.nn.functional.pad(x, flat)

kernel_name = 'parallel_sum__ssm_conv_s4__dense_activation_gelu__prompt'

def setup_inputs():

    _w = (lambda a: (lambda t: t.to(torch.bfloat16) if t.is_floating_point() else t)(torch.as_tensor(a)))
    def _A_setup():
        B, L, D, N = 1, 2048, 640, 128
        A_re = -(lambda _x: torch.exp(torch.as_tensor(_x)))((lambda *s: torch.randn(*s, dtype=torch.bfloat16) * 6.4)(D, N))
        A_im = torch.pi * (lambda *s: torch.randn(*s, dtype=torch.bfloat16) * 0.05)(D, N)
        B_re = (lambda *s: torch.randn(*s, dtype=torch.bfloat16) * 0.1)(D, N)
        B_im = (lambda *s: torch.randn(*s, dtype=torch.bfloat16) * 0.1)(D, N)
        C_re = (lambda *s: torch.randn(*s, dtype=torch.bfloat16) * 0.1)(D, N)
        C_im = (lambda *s: torch.randn(*s, dtype=torch.bfloat16) * 0.1)(D, N)
        log_dt = (lambda *s: torch.randn(*s, dtype=torch.bfloat16) * 0.05)(D) * 0.5 - 4.0
        Dskip = (lambda *s: torch.randn(*s, dtype=torch.bfloat16) * 0.05)(D)
        return {
            "u": _w((lambda *s: torch.randn(*s, dtype=torch.bfloat16) * 0.05)(B, L, D)),
            "A_re": _w(A_re),
            "A_im": _w(A_im),
            "B_re": _w(B_re),
            "B_im": _w(B_im),
            "C_re": _w(C_re),
            "C_im": _w(C_im),
            "log_dt": _w(log_dt),
            "Dskip": _w(Dskip),
        }
    _A_in = _A_setup()

    def _B_setup():
        B, S, D, F = 1, 2048, 640, 1728
        return {
            "x": _w((lambda *s: torch.randn(*s, dtype=torch.bfloat16) * 0.05)(B, S, D)),
            "w1": _w((lambda *s: torch.randn(*s, dtype=torch.bfloat16) * 0.8)(D, F) * (D ** -0.5)),
            "b1": _w((lambda *s: torch.randn(*s, dtype=torch.bfloat16) * 0.2)(F) * 0.01),
            "w2": _w((lambda *s: torch.randn(*s, dtype=torch.bfloat16) * 0.2)(F, D) * (F ** -0.5)),
            "b2": _w((lambda *s: torch.randn(*s, dtype=torch.bfloat16) * 0.2)(D) * 0.01),
        }
    _B_in = _B_setup()

    return {
        "A_u": _A_in["u"],
        "A_A_re": _A_in["A_re"],
        "A_A_im": _A_in["A_im"],
        "A_B_re": _A_in["B_re"],
        "A_B_im": _A_in["B_im"],
        "A_C_re": _A_in["C_re"],
        "A_C_im": _A_in["C_im"],
        "A_log_dt": _A_in["log_dt"],
        "A_Dskip": _A_in["Dskip"],
        "B_x": _B_in["x"],
        "B_w1": _B_in["w1"],
        "B_b1": _B_in["b1"],
        "B_w2": _B_in["w2"],
        "B_b2": _B_in["b2"],
    }

def reference(A_u, A_A_re, A_A_im, A_B_re, A_B_im, A_C_re, A_C_im, A_log_dt, A_Dskip, B_x, B_w1, B_b1, B_w2, B_b2):
    def _A_ref(u, A_re, A_im, B_re, B_im, C_re, C_im, log_dt, Dskip):
        Bsz, L, D = u.shape
        dt = torch.exp(log_dt)[:, None]
        A = A_re + 1j * A_im
        Bc = B_re + 1j * B_im
        Cc = C_re + 1j * C_im
        logdA = dt * A
        dB = dt * Bc
        l = (lambda x, dt: x.to(dt))(torch.arange(L), A_re.dtype)
        P = torch.exp(logdA[:, :, None] * l[None, None, :])
        K = torch.einsum("dn,dnl,dn->dl", Cc, P, dB).real
        L2 = 2 * L
        Kp = _pad(K, ((0, 0), (0, L)))
        up = (lambda x, *d: x.permute(*d))(u, 0, 2, 1)
        up = _pad(up, ((0, 0), (0, 0), (0, L)))
        Kf = (lambda x, axes=(-2,-1): torch.fft.rfft2(x.float(), dim=axes))(Kp[:, None, :], axes=(-2, -1))
        Uf = (lambda x, axes=(-2,-1): torch.fft.rfft2(x.float(), dim=axes))(up[:, :, None, :], axes=(-2, -1))
        Yf = Uf * Kf[None, :, :, :]
        y = (lambda x, s, axes=(-2,-1): torch.fft.irfft2(x, s=s, dim=axes).to(torch.bfloat16))(Yf, (1, L2), axes=(-2, -1))[:, :, 0, :L]
        y = (lambda x, *d: x.permute(*d))(y, 0, 2, 1) + u * Dskip[None, None, :]
        return y

    def _B_ref(x, w1, b1, w2, b2):
        h = torch.einsum("bsd,df->bsf", x, w1) + b1
        h = _gelu(h)
        return torch.einsum("bsf,fd->bsd", h, w2) + b2

    x = A_u
    xn = _layernorm(x, axis=-1)
    return x + _A_ref(xn, A_A_re, A_A_im, A_B_re, A_B_im, A_C_re, A_C_im, A_log_dt, A_Dskip) + _B_ref(xn, B_w1, B_b1, B_w2, B_b2)
```

```asm
; @launch grid=(256,1,1) block=(512,1,1) lds=163840
.amdgcn_target "amdgcn-amd-amdhsa--gfx950"
.text
.globl parallel_sum__ssm_conv_s4__dense_activation_gelu__prompt_kernel
.p2align 8
.type parallel_sum__ssm_conv_s4__dense_activation_gelu__prompt_kernel,@function
parallel_sum__ssm_conv_s4__dense_activation_gelu__prompt_kernel:
KSTART:
  s_cmp_ge_u32 s2, 256
  s_cbranch_scc1 M_END
  s_load_dwordx2 s[6:7], s[0:1], 128
  s_load_dwordx2 s[4:5], s[0:1], 0
  s_load_dwordx8 s[48:55], s[0:1], 80
  s_load_dwordx16 s[60:75], s[0:1], 8
  s_mov_b32 s79, 0
  v_and_b32 v1, 63, v0
  v_lshrrev_b32 v6, 6, v0
  s_nop 0
  v_readfirstlane_b32 s12, v6
  s_and_b32 s3, s2, 7
  s_lshr_b32 s14, s2, 3
  s_lshl_b32 s101, s3, 5
  s_add_u32 s101, s101, s14
  s_and_b32 s17, s14, 3
  s_lshr_b32 s15, s3, 1
  s_lshl_b32 s15, s15, 2
  s_add_u32 s15, s15, s17
  s_lshr_b32 s45, s14, 2
  s_and_b32 s78, s3, 1
  s_mul_i32 s16, s78, 7
  s_add_u32 s16, s16, s45
  s_lshl_b32 s44, s3, 2
  s_add_u32 s44, s44, s17
  s_and_b32 s13, s12, 3
  s_cmp_eq_u32 s12, 7
  s_cbranch_scc1 M_L
  s_cmp_ge_u32 s12, 4
  s_cbranch_scc1 M_KS
  v_lshrrev_b32 v6, 5, v1
  v_and_b32 v7, 31, v1
  v_mul_u32_u24 v2, 1280, v6
  v_lshl_add_u32 v2, v7, 3, v2
  s_mul_i32 s22, s101, 10240
  s_mul_i32 s23, s13, 2560
  s_add_u32 s22, s22, s23
  s_waitcnt lgkmcnt(0)
  s_mov_b32 s24, s4
  s_and_b32 s25, s5, 0xffff
  s_mov_b32 s26, 2621440
  s_mov_b32 s27, 0x20000
  buffer_load_dwordx2 v[200:201], v2, s[24:27], s22 offen offset:0
  buffer_load_dwordx2 v[202:203], v2, s[24:27], s22 offen offset:256
  buffer_load_dwordx2 v[204:205], v2, s[24:27], s22 offen offset:512
  buffer_load_dwordx2 v[206:207], v2, s[24:27], s22 offen offset:768
  buffer_load_dwordx2 v[208:209], v2, s[24:27], s22 offen offset:1024
  s_cmp_lt_u32 s14, 28
  s_cbranch_scc1 M_G
  s_branch GC
M_KS:
  s_cmp_ge_u32 s14, 28
  s_cbranch_scc1 KC
  s_mul_i32 s59, s14, 3
  s_lshl_b32 s22, s14, 1
  s_add_u32 s22, s22, 24
  s_cmp_lt_u32 s14, 24
  s_cselect_b32 s59, s59, s22
  s_cselect_b32 s22, 3, 2
  s_cmp_ge_u32 s13, s22
  s_cbranch_scc1 M_END
  s_add_u32 s59, s59, s13
  s_mul_i32 s47, s3, 80
  s_add_u32 s47, s47, s59
  v_lshlrev_b32 v116, 2, v1
  s_lshl_b32 s76, s47, 8
  v_add_u32 v116, s76, v116
  s_lshl_b32 s76, s47, 1
  v_mov_b32 v117, s76
  s_waitcnt lgkmcnt(0)
  global_load_dword v48, v116, s[60:61]
  global_load_dword v49, v116, s[62:63]
  global_load_dword v50, v116, s[64:65]
  global_load_dword v51, v116, s[66:67]
  global_load_dword v52, v116, s[68:69]
  global_load_dword v53, v116, s[70:71]
  global_load_ushort v54, v117, s[72:73]
  global_load_ushort v55, v117, s[74:75]
  s_branch M_K
M_L:
  v_mov_b32 v26, 163328
  v_lshl_add_u32 v26, v1, 2, v26
  v_mov_b32 v28, 0
  ds_write_b32 v26, v28
  s_cmp_ge_u32 s14, 28
  s_cbranch_scc1 LC
  s_setprio 3
  s_mul_i32 s17, s17, 5
  s_mul_i32 s22, s45, 3
  s_add_u32 s17, s17, s22
  s_mul_i32 s22, s3, 1
  s_add_u32 s17, s17, s22
  s_lshr_b32 s17, s17, 1
  s_mul_i32 s22, s17, 6554
  s_lshr_b32 s22, s22, 16
  s_mul_i32 s22, s22, 10
  s_sub_u32 s17, s17, s22
  v_lshrrev_b32 v22, 4, v1
  v_bfe_u32 v21, v1, 1, 3
  v_xor_b32 v21, v21, v22
  v_and_b32 v23, 1, v1
  v_lshl_add_u32 v21, v21, 1, v23
  v_xor_b32 v23, 8, v21
  v_mul_u32_u24 v24, 3456, v22
  v_lshl_add_u32 v10, v21, 4, v24
  v_lshl_add_u32 v11, v23, 4, v24
  s_cmp_eq_u32 s16, 13
  s_cselect_b32 s22, 8, 16
  v_mov_b32 v25, 0x7f000000
  v_cmp_gt_u32 vcc, s22, v21
  s_nop 1
  v_cndmask_b32 v10, v25, v10, vcc
  v_cmp_gt_u32 vcc, s22, v23
  s_nop 1
  v_cndmask_b32 v11, v25, v11, vcc
  v_add_u32 v12, 53248, v10
  v_add_u32 v13, 79872, v11
  v_add_u32 v11, 26624, v11
  v_lshrrev_b32 v20, 3, v1
  v_and_b32 v21, 7, v1
  v_xor_b32 v21, v21, v22
  v_mul_u32_u24 v2, 1280, v20
  v_lshl_add_u32 v2, v21, 4, v2
  v_xor_b32 v6, 64, v2
  v_add_u32 v3, 19456, v2
  v_add_u32 v7, 19456, v6
  v_add_u32 v4, 38912, v2
  v_add_u32 v8, 38912, v6
  v_add_u32 v5, 58368, v2
  v_add_u32 v9, 58368, v6
  s_mul_i32 s18, s15, 163840
  s_lshl_b32 s20, s16, 8
  s_mov_b32 s19, 0
  s_mov_b32 s40, 0
  s_waitcnt lgkmcnt(0)
  s_mov_b32 s24, s4
  s_and_b32 s25, s5, 0xffff
  s_mov_b32 s26, 2621440
  s_mov_b32 s27, 0x20000
  s_mov_b32 s28, s48
  s_and_b32 s29, s49, 0xffff
  s_mov_b32 s30, 2211840
  s_mov_b32 s31, 0x20000
  s_add_u32 s8, s6, 27262976
  s_addc_u32 s9, s7, 0
  s_load_dword s100, s[8:9], 0
  s_mov_b32 s36, s6
  s_and_b32 s37, s7, 0xffff
  s_mov_b32 s38, 33554432
  s_mov_b32 s39, 0x20000
L_P:
  s_lshl_b32 s22, s17, 7
  s_add_u32 s22, s22, s18
  s_mul_i32 s23, s17, 221184
  s_add_u32 s23, s23, s20
  s_add_u32 m0, s19, 16384
  s_add_u32 s41, s23, 0
  buffer_load_dwordx4 v10, s[28:31], s41 offen offset:0 lds
  buffer_load_dwordx4 v11, s[28:31], s41 offen offset:1024 lds
  buffer_load_dwordx4 v12, s[28:31], s41 offen offset:2048 lds
  buffer_load_dwordx4 v13, s[28:31], s41 offen offset:3072 lds
  s_add_u32 m0, s19, 0
  s_add_u32 s41, s22, 0
  buffer_load_dwordx4 v2, s[24:27], s41 offen offset:0 lds
  buffer_load_dwordx4 v3, s[24:27], s41 offen offset:1024 lds
  buffer_load_dwordx4 v4, s[24:27], s41 offen offset:2048 lds
  buffer_load_dwordx4 v5, s[24:27], s41 offen offset:3072 lds
  s_add_u32 m0, s19, 20480
  s_add_u32 s41, s23, 13824
  buffer_load_dwordx4 v10, s[28:31], s41 offen offset:0 lds
  buffer_load_dwordx4 v11, s[28:31], s41 offen offset:1024 lds
  buffer_load_dwordx4 v12, s[28:31], s41 offen offset:2048 lds
  buffer_load_dwordx4 v13, s[28:31], s41 offen offset:3072 lds
  s_add_u32 m0, s19, 4096
  s_add_u32 s41, s22, 10240
  buffer_load_dwordx4 v6, s[24:27], s41 offen offset:0 lds
  buffer_load_dwordx4 v7, s[24:27], s41 offen offset:1024 lds
  buffer_load_dwordx4 v8, s[24:27], s41 offen offset:2048 lds
  buffer_load_dwordx4 v9, s[24:27], s41 offen offset:3072 lds
  s_add_u32 m0, s19, 24576
  s_add_u32 s41, s23, 110592
  buffer_load_dwordx4 v10, s[28:31], s41 offen offset:0 lds
  buffer_load_dwordx4 v11, s[28:31], s41 offen offset:1024 lds
  buffer_load_dwordx4 v12, s[28:31], s41 offen offset:2048 lds
  buffer_load_dwordx4 v13, s[28:31], s41 offen offset:3072 lds
  s_add_u32 m0, s19, 8192
  s_add_u32 s41, s22, 81920
  buffer_load_dwordx4 v2, s[24:27], s41 offen offset:0 lds
  buffer_load_dwordx4 v3, s[24:27], s41 offen offset:1024 lds
  buffer_load_dwordx4 v4, s[24:27], s41 offen offset:2048 lds
  buffer_load_dwordx4 v5, s[24:27], s41 offen offset:3072 lds
  s_add_u32 m0, s19, 28672
  s_add_u32 s41, s23, 124416
  buffer_load_dwordx4 v10, s[28:31], s41 offen offset:0 lds
  buffer_load_dwordx4 v11, s[28:31], s41 offen offset:1024 lds
  buffer_load_dwordx4 v12, s[28:31], s41 offen offset:2048 lds
  buffer_load_dwordx4 v13, s[28:31], s41 offen offset:3072 lds
  s_waitcnt vmcnt(59)
  s_add_u32 m0, s19, 12288
  s_add_u32 s41, s22, 92160
  buffer_load_dwordx4 v6, s[24:27], s41 offen offset:0 lds
  buffer_load_dwordx4 v7, s[24:27], s41 offen offset:1024 lds
  buffer_load_dwordx4 v8, s[24:27], s41 offen offset:2048 lds
  buffer_load_dwordx4 v9, s[24:27], s41 offen offset:3072 lds
  s_add_u32 s17, s17, 1
  s_cmp_eq_u32 s17, 10
  s_cselect_b32 s17, 0, s17
  s_add_u32 s19, s19, 32768
  s_cmp_eq_u32 s19, 98304
  s_cselect_b32 s19, 0, s19
  s_add_u32 s40, s40, 1
  s_cmp_lt_u32 s40, 2
  s_cbranch_scc1 L_P
  s_waitcnt lgkmcnt(0)
  s_mul_i32 s100, s100, 1664525
  s_add_u32 s100, s100, 1013904223
  s_or_b32 s100, s100, 0x100
  s_load_dwordx2 s[8:9], s[0:1], 96
  v_add_u32 v36, 0, v1
  v_mul_u32_u24 v37, 6554, v36
  v_lshrrev_b32 v37, 16, v37
  v_mul_u32_u24 v37, 1120, v37
  v_lshl_add_u32 v14, v1, 4, v37
  v_add_u32 v36, 64, v1
  v_mul_u32_u24 v37, 6554, v36
  v_lshrrev_b32 v37, 16, v37
  v_mul_u32_u24 v37, 1120, v37
  v_lshl_add_u32 v15, v1, 4, v37
  v_add_u32 v36, 128, v1
  v_mul_u32_u24 v37, 6554, v36
  v_lshrrev_b32 v37, 16, v37
  v_mul_u32_u24 v37, 1120, v37
  v_lshl_add_u32 v16, v1, 4, v37
  v_add_u32 v36, 192, v1
  v_mul_u32_u24 v37, 6554, v36
  v_lshrrev_b32 v37, 16, v37
  v_mul_u32_u24 v37, 1120, v37
  v_lshl_add_u32 v17, v1, 4, v37
  v_add_u32 v36, 256, v1
  v_mul_u32_u24 v37, 6554, v36
  v_lshrrev_b32 v37, 16, v37
  v_mul_u32_u24 v37, 1120, v37
  v_lshl_add_u32 v18, v36, 4, v37
  s_waitcnt lgkmcnt(0)
  s_mov_b32 s32, s8
  s_and_b32 s33, s9, 0xffff
  s_mov_b32 s34, 2211840
  s_mov_b32 s35, 0x20000
  s_and_b32 s46, s14, 3
  s_mul_i32 s46, s46, 7
  s_lshr_b32 s22, s3, 1
  s_mul_i32 s22, s22, 2
  s_add_u32 s46, s46, s22
  s_lshr_b32 s22, s14, 2
  s_mul_i32 s22, s22, 7
  s_lshr_b32 s22, s22, 1
  s_add_u32 s46, s46, s22
  s_and_b32 s78, s3, 1
  s_lshl_b32 s64, s78, 1
  s_sub_u32 s64, 28, s64
  s_sub_u32 s22, s46, s64
  s_cmp_ge_u32 s46, s64
  s_cselect_b32 s46, s22, s46
  s_sub_u32 s22, s46, s64
  s_cmp_ge_u32 s46, s64
  s_cselect_b32 s46, s22, s46
  s_mul_i32 s57, s45, 160
  s_mul_i32 s22, s78, 1146880
  s_add_u32 s57, s57, s22
  v_and_b32 v46, 3, v1
  v_lshlrev_b32 v46, 2, v46
  v_add_u32 v46, 163336, v46
  v_lshrrev_b32 v49, 5, v1
  v_mul_u32_u24 v49, 55296, v49
  v_and_b32 v30, 31, v1
  v_lshl_add_u32 v49, v30, 7, v49
  s_mul_i32 s68, s15, 442368
  s_lshl_b32 s22, s16, 12
  s_add_u32 s68, s68, s22
  v_and_b32 v30, 7, v1
  v_lshlrev_b32 v30, 7, v30
  s_mov_b32 s59, 27264000
  v_add_u32 v36, 0, v1
  v_mul_u32_u24 v37, 21846, v36
  v_lshrrev_b32 v37, 16, v37
  v_mul_u32_u24 v37, 10192, v37
  v_lshl_add_u32 v40, v1, 4, v37
  v_add_u32 v36, 64, v1
  v_mul_u32_u24 v37, 21846, v36
  v_lshrrev_b32 v37, 16, v37
  v_mul_u32_u24 v37, 10192, v37
  v_lshl_add_u32 v41, v1, 4, v37
  v_add_u32 v36, 128, v1
  v_mul_u32_u24 v37, 21846, v36
  v_lshrrev_b32 v37, 16, v37
  v_mul_u32_u24 v37, 10192, v37
  v_lshl_add_u32 v42, v1, 4, v37
  s_mul_i32 s65, s14, 3
  s_lshl_b32 s22, s14, 1
  s_add_u32 s22, s22, 24
  s_cmp_lt_u32 s14, 24
  s_cselect_b32 s65, s65, s22
  s_mul_i32 s23, s3, 80
  s_add_u32 s65, s65, s23
  s_lshl_b32 s65, s65, 4
  s_add_u32 s65, s65, 12582912
  s_cmp_lt_u32 s14, 28
  s_cselect_b32 s65, s65, 0x7f000000
  v_mov_b32 v44, 163328
  v_mov_b32 v45, s100
  s_mov_b32 s42, 0
L_LOOP:
  s_waitcnt vmcnt(32)
  s_barrier
  s_lshl_b32 s22, s17, 7
  s_add_u32 s22, s22, s18
  s_mul_i32 s23, s17, 221184
  s_add_u32 s23, s23, s20
  s_add_u32 m0, s19, 16384
  s_add_u32 s41, s23, 0
  buffer_load_dwordx4 v10, s[28:31], s41 offen offset:0 lds
  buffer_load_dwordx4 v11, s[28:31], s41 offen offset:1024 lds
  buffer_load_dwordx4 v12, s[28:31], s41 offen offset:2048 lds
  buffer_load_dwordx4 v13, s[28:31], s41 offen offset:3072 lds
  s_add_u32 m0, s19, 0
  s_add_u32 s41, s22, 0
  buffer_load_dwordx4 v2, s[24:27], s41 offen offset:0 lds
  buffer_load_dwordx4 v3, s[24:27], s41 offen offset:1024 lds
  buffer_load_dwordx4 v4, s[24:27], s41 offen offset:2048 lds
  buffer_load_dwordx4 v5, s[24:27], s41 offen offset:3072 lds
  s_add_u32 m0, s19, 20480
  s_add_u32 s41, s23, 13824
  buffer_load_dwordx4 v10, s[28:31], s41 offen offset:0 lds
  buffer_load_dwordx4 v11, s[28:31], s41 offen offset:1024 lds
  buffer_load_dwordx4 v12, s[28:31], s41 offen offset:2048 lds
  buffer_load_dwordx4 v13, s[28:31], s41 offen offset:3072 lds
  s_add_u32 m0, s19, 4096
  s_add_u32 s41, s22, 10240
  buffer_load_dwordx4 v6, s[24:27], s41 offen offset:0 lds
  buffer_load_dwordx4 v7, s[24:27], s41 offen offset:1024 lds
  buffer_load_dwordx4 v8, s[24:27], s41 offen offset:2048 lds
  buffer_load_dwordx4 v9, s[24:27], s41 offen offset:3072 lds
  s_add_u32 m0, s19, 24576
  s_add_u32 s41, s23, 110592
  buffer_load_dwordx4 v10, s[28:31], s41 offen offset:0 lds
  buffer_load_dwordx4 v11, s[28:31], s41 offen offset:1024 lds
  buffer_load_dwordx4 v12, s[28:31], s41 offen offset:2048 lds
  buffer_load_dwordx4 v13, s[28:31], s41 offen offset:3072 lds
  s_add_u32 m0, s19, 8192
  s_add_u32 s41, s22, 81920
  buffer_load_dwordx4 v2, s[24:27], s41 offen offset:0 lds
  buffer_load_dwordx4 v3, s[24:27], s41 offen offset:1024 lds
  buffer_load_dwordx4 v4, s[24:27], s41 offen offset:2048 lds
  buffer_load_dwordx4 v5, s[24:27], s41 offen offset:3072 lds
  s_add_u32 m0, s19, 28672
  s_add_u32 s41, s23, 124416
  buffer_load_dwordx4 v10, s[28:31], s41 offen offset:0 lds
  buffer_load_dwordx4 v11, s[28:31], s41 offen offset:1024 lds
  buffer_load_dwordx4 v12, s[28:31], s41 offen offset:2048 lds
  buffer_load_dwordx4 v13, s[28:31], s41 offen offset:3072 lds
  s_waitcnt vmcnt(59)
  s_add_u32 m0, s19, 12288
  s_add_u32 s41, s22, 92160
  buffer_load_dwordx4 v6, s[24:27], s41 offen offset:0 lds
  buffer_load_dwordx4 v7, s[24:27], s41 offen offset:1024 lds
  buffer_load_dwordx4 v8, s[24:27], s41 offen offset:2048 lds
  buffer_load_dwordx4 v9, s[24:27], s41 offen offset:3072 lds
  s_add_u32 s17, s17, 1
  s_cmp_eq_u32 s17, 10
  s_cselect_b32 s17, 0, s17
  s_add_u32 s19, s19, 32768
  s_cmp_eq_u32 s19, 98304
  s_cselect_b32 s19, 0, s19
  s_add_u32 s40, s40, 1
  s_cmp_lt_u32 s40, 10
  s_cbranch_scc1 L_LOOP
  s_waitcnt vmcnt(32)
  s_barrier
  buffer_load_dword v32, v30, s[36:39], s59 offen sc1
  s_mov_b32 s43, 142848
  s_mov_b32 s42, 0
UN_1:
  s_mul_i32 s41, s46, 40960
  s_add_u32 s41, s41, s57
  s_mov_b32 m0, s43
  s_nop 0
  buffer_load_dwordx4 v14, s[32:35], s41 offen offset:0 lds
  buffer_load_dwordx4 v15, s[32:35], s41 offen offset:1024 lds
  buffer_load_dwordx4 v16, s[32:35], s41 offen offset:2048 lds
  buffer_load_dwordx4 v17, s[32:35], s41 offen offset:3072 lds
  s_add_u32 m0, s43, 4096
  s_add_u32 s43, s43, 5120
  buffer_load_dwordx4 v18, s[32:35], s41 offen lds
  s_add_u32 s46, s46, 1
  s_cmp_eq_u32 s46, s64
  s_cselect_b32 s46, 0, s46
  s_add_u32 s42, s42, 1
  s_cmp_lt_u32 s42, 4
  s_cbranch_scc1 UN_1
  s_waitcnt vmcnt(20)
  s_barrier
  v_cmp_ne_u32 vcc, s100, v32
  s_cbranch_vccz LW_U
  s_branch LW_P2
LW_POLL:
  s_branch PF_3
PG_2:
  s_sleep 4
PF_3:
  buffer_load_dword v32, v30, s[36:39], s59 offen sc1
  s_waitcnt vmcnt(0)
  v_cmp_ne_u32 vcc, s100, v32
  s_cbranch_vccz CT_4
  s_add_u32 s79, s79, 1
  s_cmp_lt_u32 s79, 20000
  s_cbranch_scc1 PG_2
CT_4:
  s_mov_b32 s43, 142848
  s_mov_b32 s42, 0
UN_5:
  s_mul_i32 s41, s46, 40960
  s_add_u32 s41, s41, s57
  s_waitcnt vmcnt(19)
  s_mov_b32 m0, s43
  s_nop 0
  buffer_load_dwordx4 v14, s[32:35], s41 offen offset:0 lds
  buffer_load_dwordx4 v15, s[32:35], s41 offen offset:1024 lds
  buffer_load_dwordx4 v16, s[32:35], s41 offen offset:2048 lds
  buffer_load_dwordx4 v17, s[32:35], s41 offen offset:3072 lds
  s_add_u32 m0, s43, 4096
  s_add_u32 s43, s43, 5120
  buffer_load_dwordx4 v18, s[32:35], s41 offen lds
  s_add_u32 s46, s46, 1
  s_cmp_eq_u32 s46, s64
  s_cselect_b32 s46, 0, s46
  s_add_u32 s42, s42, 1
  s_cmp_lt_u32 s42, 4
  s_cbranch_scc1 UN_5
LW_P2:
  s_branch PF_7
PG_6:
  s_sleep 4
PF_7:
  buffer_load_dword v32, v30, s[36:39], s59 offen sc1
  s_waitcnt vmcnt(0)
  v_cmp_ne_u32 vcc, s100, v32
  s_cbranch_vccz CT_8
  s_add_u32 s79, s79, 1
  s_cmp_lt_u32 s79, 20000
  s_cbranch_scc1 PG_6
CT_8:
LW_U:
  s_mov_b32 m0, 130464
  s_nop 0
  buffer_load_dwordx4 v40, s[36:39], s65 offen offset:0 sc1 lds
  buffer_load_dwordx4 v41, s[36:39], s65 offen offset:1024 sc1 lds
  buffer_load_dwordx4 v42, s[36:39], s65 offen offset:2048 sc1 lds
  s_add_u32 s65, s65, 655360
  s_mov_b32 m0, 133536
  s_nop 0
  buffer_load_dwordx4 v40, s[36:39], s65 offen offset:0 sc1 lds
  buffer_load_dwordx4 v41, s[36:39], s65 offen offset:1024 sc1 lds
  buffer_load_dwordx4 v42, s[36:39], s65 offen offset:2048 sc1 lds
  s_add_u32 s65, s65, 655360
  s_mov_b32 m0, 136608
  s_nop 0
  buffer_load_dwordx4 v40, s[36:39], s65 offen offset:0 sc1 lds
  buffer_load_dwordx4 v41, s[36:39], s65 offen offset:1024 sc1 lds
  buffer_load_dwordx4 v42, s[36:39], s65 offen offset:2048 sc1 lds
  s_add_u32 s65, s65, 655360
  s_mov_b32 m0, 139680
  s_nop 0
  buffer_load_dwordx4 v40, s[36:39], s65 offen offset:0 sc1 lds
  buffer_load_dwordx4 v41, s[36:39], s65 offen offset:1024 sc1 lds
  buffer_load_dwordx4 v42, s[36:39], s65 offen offset:2048 sc1 lds
  s_mov_b32 s43, 32768
  s_mov_b32 s42, 4
UN_9:
  s_mul_i32 s41, s46, 40960
  s_add_u32 s41, s41, s57
  s_waitcnt vmcnt(19)
  s_mov_b32 m0, s43
  s_nop 0
  buffer_load_dwordx4 v14, s[32:35], s41 offen offset:0 lds
  buffer_load_dwordx4 v15, s[32:35], s41 offen offset:1024 lds
  buffer_load_dwordx4 v16, s[32:35], s41 offen offset:2048 lds
  buffer_load_dwordx4 v17, s[32:35], s41 offen offset:3072 lds
  s_add_u32 m0, s43, 4096
  s_add_u32 s43, s43, 5120
  buffer_load_dwordx4 v18, s[32:35], s41 offen lds
  s_add_u32 s46, s46, 1
  s_cmp_eq_u32 s46, s64
  s_cselect_b32 s46, 0, s46
  s_add_u32 s42, s42, 1
  s_cmp_lt_u32 s42, 8
  s_cbranch_scc1 UN_9
  s_waitcnt vmcnt(20)
  v_mov_b32 v47, s100
  s_mov_b64 exec, 1
  ds_write_b32 v44, v47 offset:4
  s_mov_b64 exec, -1
  v_mov_b32 v47, 4
  s_mov_b64 exec, 1
  ds_write_b32 v44, v47 offset:0
  s_mov_b64 exec, -1
  s_mov_b32 s43, 53248
  s_mov_b32 s42, 8
UN_10:
  s_mul_i32 s41, s46, 40960
  s_add_u32 s41, s41, s57
  s_waitcnt vmcnt(19)
  s_mov_b32 m0, s43
  s_nop 0
  buffer_load_dwordx4 v14, s[32:35], s41 offen offset:0 lds
  buffer_load_dwordx4 v15, s[32:35], s41 offen offset:1024 lds
  buffer_load_dwordx4 v16, s[32:35], s41 offen offset:2048 lds
  buffer_load_dwordx4 v17, s[32:35], s41 offen offset:3072 lds
  s_add_u32 m0, s43, 4096
  s_add_u32 s43, s43, 5120
  buffer_load_dwordx4 v18, s[32:35], s41 offen lds
  s_add_u32 s46, s46, 1
  s_cmp_eq_u32 s46, s64
  s_cselect_b32 s46, 0, s46
  s_add_u32 s42, s42, 1
  s_cmp_lt_u32 s42, 14
  s_cbranch_scc1 UN_10
  s_waitcnt vmcnt(20)
  v_mov_b32 v47, 10
  s_mov_b64 exec, 1
  ds_write_b32 v44, v47 offset:0
  s_mov_b64 exec, -1
  s_mov_b32 s43, 83968
  s_mov_b32 s42, 14
UN_11:
  s_mul_i32 s41, s46, 40960
  s_add_u32 s41, s41, s57
  s_waitcnt vmcnt(19)
  s_mov_b32 m0, s43
  s_nop 0
  buffer_load_dwordx4 v14, s[32:35], s41 offen offset:0 lds
  buffer_load_dwordx4 v15, s[32:35], s41 offen offset:1024 lds
  buffer_load_dwordx4 v16, s[32:35], s41 offen offset:2048 lds
  buffer_load_dwordx4 v17, s[32:35], s41 offen offset:3072 lds
  s_add_u32 m0, s43, 4096
  s_add_u32 s43, s43, 5120
  buffer_load_dwordx4 v18, s[32:35], s41 offen lds
  s_add_u32 s46, s46, 1
  s_cmp_eq_u32 s46, s64
  s_cselect_b32 s46, 0, s46
  s_add_u32 s42, s42, 1
  s_cmp_lt_u32 s42, 16
  s_cbranch_scc1 UN_11
SG_12:
  ds_read_b32 v48, v46
  s_waitcnt lgkmcnt(0)
  v_cmp_gt_u32 vcc, 1, v48
  s_cbranch_vccz SO_13
  s_sleep 1
  s_add_u32 s79, s79, 1
  s_cmp_lt_u32 s79, 200000
  s_cbranch_scc1 SG_12
SO_13:
  s_mov_b32 s43, 0
  s_mov_b32 s42, 16
UN_14:
  s_mul_i32 s41, s46, 40960
  s_add_u32 s41, s41, s57
  s_waitcnt vmcnt(19)
  s_mov_b32 m0, s43
  s_nop 0
  buffer_load_dwordx4 v14, s[32:35], s41 offen offset:0 lds
  buffer_load_dwordx4 v15, s[32:35], s41 offen offset:1024 lds
  buffer_load_dwordx4 v16, s[32:35], s41 offen offset:2048 lds
  buffer_load_dwordx4 v17, s[32:35], s41 offen offset:3072 lds
  s_add_u32 m0, s43, 4096
  s_add_u32 s43, s43, 5120
  buffer_load_dwordx4 v18, s[32:35], s41 offen lds
  s_add_u32 s46, s46, 1
  s_cmp_eq_u32 s46, s64
  s_cselect_b32 s46, 0, s46
  s_add_u32 s42, s42, 1
  s_cmp_lt_u32 s42, 20
  s_cbranch_scc1 UN_14
  s_waitcnt vmcnt(20)
  v_mov_b32 v47, 16
  s_mov_b64 exec, 1
  ds_write_b32 v44, v47 offset:0
  s_mov_b64 exec, -1
  s_mov_b32 s43, 20480
  s_mov_b32 s42, 20
UN_15:
  s_mul_i32 s41, s46, 40960
  s_add_u32 s41, s41, s57
  s_waitcnt vmcnt(19)
  s_mov_b32 m0, s43
  s_nop 0
  buffer_load_dwordx4 v14, s[32:35], s41 offen offset:0 lds
  buffer_load_dwordx4 v15, s[32:35], s41 offen offset:1024 lds
  buffer_load_dwordx4 v16, s[32:35], s41 offen offset:2048 lds
  buffer_load_dwordx4 v17, s[32:35], s41 offen offset:3072 lds
  s_add_u32 m0, s43, 4096
  s_add_u32 s43, s43, 5120
  buffer_load_dwordx4 v18, s[32:35], s41 offen lds
  s_add_u32 s46, s46, 1
  s_cmp_eq_u32 s46, s64
  s_cselect_b32 s46, 0, s46
  s_add_u32 s42, s42, 1
  s_cmp_lt_u32 s42, 22
  s_cbranch_scc1 UN_15
  s_waitcnt vmcnt(0)
  v_mov_b32 v47, 22
  s_mov_b64 exec, 1
  ds_write_b32 v44, v47 offset:0
  s_mov_b64 exec, -1
SG_16:
  ds_read_b32 v48, v46
  s_waitcnt lgkmcnt(0)
  v_cmp_gt_u32 vcc, 3, v48
  s_cbranch_vccz SO_17
  s_sleep 1
  s_add_u32 s79, s79, 1
  s_cmp_lt_u32 s79, 200000
  s_cbranch_scc1 SG_16
SO_17:
  s_mov_b32 s43, 142848
  s_mov_b32 s42, 22
UN_18:
  s_mul_i32 s41, s46, 40960
  s_add_u32 s41, s41, s57
  s_waitcnt vmcnt(19)
  s_mov_b32 m0, s43
  s_nop 0
  buffer_load_dwordx4 v14, s[32:35], s41 offen offset:0 lds
  buffer_load_dwordx4 v15, s[32:35], s41 offen offset:1024 lds
  buffer_load_dwordx4 v16, s[32:35], s41 offen offset:2048 lds
  buffer_load_dwordx4 v17, s[32:35], s41 offen offset:3072 lds
  s_add_u32 m0, s43, 4096
  s_add_u32 s43, s43, 5120
  buffer_load_dwordx4 v18, s[32:35], s41 offen lds
  s_add_u32 s46, s46, 1
  s_cmp_eq_u32 s46, s64
  s_cselect_b32 s46, 0, s46
  s_add_u32 s42, s42, 1
  s_cmp_lt_u32 s42, 26
  s_cbranch_scc1 UN_18
  s_mov_b32 s43, 32768
  s_mov_b32 s42, 26
UN_19:
  s_mul_i32 s41, s46, 40960
  s_add_u32 s41, s41, s57
  s_cmp_lt_u32 s42, s64
  s_cselect_b32 s41, s41, 0x7f000000
  s_waitcnt vmcnt(19)
  s_mov_b32 m0, s43
  s_nop 0
  buffer_load_dwordx4 v14, s[32:35], s41 offen offset:0 lds
  buffer_load_dwordx4 v15, s[32:35], s41 offen offset:1024 lds
  buffer_load_dwordx4 v16, s[32:35], s41 offen offset:2048 lds
  buffer_load_dwordx4 v17, s[32:35], s41 offen offset:3072 lds
  s_add_u32 m0, s43, 4096
  s_add_u32 s43, s43, 5120
  buffer_load_dwordx4 v18, s[32:35], s41 offen lds
  s_add_u32 s46, s46, 1
  s_cmp_eq_u32 s46, s64
  s_cselect_b32 s46, 0, s46
  s_add_u32 s42, s42, 1
  s_cmp_lt_u32 s42, 28
  s_cbranch_scc1 UN_19
  s_waitcnt vmcnt(0)
  v_mov_b32 v47, 28
  s_mov_b64 exec, 1
  ds_write_b32 v44, v47 offset:0
  s_mov_b64 exec, -1
  s_endpgm
LC:
  s_getpc_b64 s[10:11]
PC_20:
  s_sub_u32 s10, s10, PC_20-KSTART
  s_subb_u32 s11, s11, 0
  v_lshlrev_b32 v55, 7, v1
  s_and_b32 s22, s14, 3
  s_lshl_b32 s22, s22, 14
  v_add_u32 v55, s22, v55
  v_min_u32 v52, M_END-KSTART, v55
  v_mov_b32 v53, s11
  v_add_co_u32 v52, vcc, s10, v52
  s_nop 1
  v_addc_co_u32 v53, vcc, 0, v53, vcc
  global_load_dword v56, v[52:53], off sc1
  v_add_u32 v55, 8192, v55
  v_min_u32 v52, M_END-KSTART, v55
  v_mov_b32 v53, s11
  v_add_co_u32 v52, vcc, s10, v52
  s_nop 1
  v_addc_co_u32 v53, vcc, 0, v53, vcc
  global_load_dword v56, v[52:53], off sc1
  v_add_u32 v55, 8192, v55
  s_waitcnt lgkmcnt(0)
  s_add_u32 s8, s6, 27262976
  s_addc_u32 s9, s7, 0
  s_load_dword s100, s[8:9], 0
  s_mov_b32 s36, s6
  s_and_b32 s37, s7, 0xffff
  s_mov_b32 s38, 33554432
  s_mov_b32 s39, 0x20000
  s_waitcnt lgkmcnt(0)
  s_mul_i32 s100, s100, 1664525
  s_add_u32 s100, s100, 1013904223
  s_or_b32 s100, s100, 0x100
  s_load_dwordx2 s[8:9], s[0:1], 96
  v_add_u32 v36, 0, v1
  v_mul_u32_u24 v37, 6554, v36
  v_lshrrev_b32 v37, 16, v37
  v_mul_u32_u24 v37, 1120, v37
  v_lshl_add_u32 v14, v1, 4, v37
  v_add_u32 v36, 64, v1
  v_mul_u32_u24 v37, 6554, v36
  v_lshrrev_b32 v37, 16, v37
  v_mul_u32_u24 v37, 1120, v37
  v_lshl_add_u32 v15, v1, 4, v37
  v_add_u32 v36, 128, v1
  v_mul_u32_u24 v37, 6554, v36
  v_lshrrev_b32 v37, 16, v37
  v_mul_u32_u24 v37, 1120, v37
  v_lshl_add_u32 v16, v1, 4, v37
  v_add_u32 v36, 192, v1
  v_mul_u32_u24 v37, 6554, v36
  v_lshrrev_b32 v37, 16, v37
  v_mul_u32_u24 v37, 1120, v37
  v_lshl_add_u32 v17, v1, 4, v37
  v_add_u32 v36, 256, v1
  v_mul_u32_u24 v37, 6554, v36
  v_lshrrev_b32 v37, 16, v37
  v_mul_u32_u24 v37, 1120, v37
  v_lshl_add_u32 v18, v36, 4, v37
  s_waitcnt lgkmcnt(0)
  s_mov_b32 s32, s8
  s_and_b32 s33, s9, 0xffff
  s_mov_b32 s34, 2211840
  s_mov_b32 s35, 0x20000
  s_and_b32 s46, s14, 3
  s_mul_i32 s46, s46, 7
  s_lshr_b32 s22, s3, 1
  s_mul_i32 s22, s22, 2
  s_add_u32 s46, s46, s22
  s_lshr_b32 s22, s14, 2
  s_mul_i32 s22, s22, 7
  s_lshr_b32 s22, s22, 1
  s_add_u32 s46, s46, s22
  s_and_b32 s78, s3, 1
  s_lshl_b32 s64, s78, 1
  s_sub_u32 s64, 28, s64
  s_sub_u32 s22, s46, s64
  s_cmp_ge_u32 s46, s64
  s_cselect_b32 s46, s22, s46
  s_sub_u32 s22, s46, s64
  s_cmp_ge_u32 s46, s64
  s_cselect_b32 s46, s22, s46
  s_mul_i32 s57, s45, 160
  s_mul_i32 s22, s78, 1146880
  s_add_u32 s57, s57, s22
  v_and_b32 v46, 3, v1
  v_lshlrev_b32 v46, 2, v46
  v_add_u32 v46, 163336, v46
  v_lshrrev_b32 v49, 5, v1
  v_mul_u32_u24 v49, 55296, v49
  v_and_b32 v30, 31, v1
  v_lshl_add_u32 v49, v30, 7, v49
  s_mul_i32 s68, s15, 442368
  s_lshl_b32 s22, s16, 12
  s_add_u32 s68, s68, s22
  v_and_b32 v30, 7, v1
  v_lshlrev_b32 v30, 7, v30
  s_mov_b32 s59, 27264000
  v_add_u32 v36, 0, v1
  v_mul_u32_u24 v37, 21846, v36
  v_lshrrev_b32 v37, 16, v37
  v_mul_u32_u24 v37, 10192, v37
  v_lshl_add_u32 v40, v1, 4, v37
  v_add_u32 v36, 64, v1
  v_mul_u32_u24 v37, 21846, v36
  v_lshrrev_b32 v37, 16, v37
  v_mul_u32_u24 v37, 10192, v37
  v_lshl_add_u32 v41, v1, 4, v37
  v_add_u32 v36, 128, v1
  v_mul_u32_u24 v37, 21846, v36
  v_lshrrev_b32 v37, 16, v37
  v_mul_u32_u24 v37, 10192, v37
  v_lshl_add_u32 v42, v1, 4, v37
  s_mul_i32 s65, s14, 3
  s_lshl_b32 s22, s14, 1
  s_add_u32 s22, s22, 24
  s_cmp_lt_u32 s14, 24
  s_cselect_b32 s65, s65, s22
  s_mul_i32 s23, s3, 80
  s_add_u32 s65, s65, s23
  s_lshl_b32 s65, s65, 4
  s_add_u32 s65, s65, 12582912
  s_cmp_lt_u32 s14, 28
  s_cselect_b32 s65, s65, 0x7f000000
  v_mov_b32 v44, 163328
  v_mov_b32 v45, s100
  s_mov_b32 s42, 0
  s_barrier
  s_branch LW_POLL
M_K:
  s_add_u32 s8, s6, 27262976
  s_addc_u32 s9, s7, 0
  s_load_dword s100, s[8:9], 0
  s_mov_b32 s36, s6
  s_and_b32 s37, s7, 0xffff
  s_mov_b32 s38, 33554432
  s_mov_b32 s39, 0x20000
  s_mul_i32 s46, s13, 10240
  s_add_u32 s46, s46, 98304
  s_lshl_b32 s45, s13, 4
  s_add_u32 s45, s45, 129024
  v_lshlrev_b32 v116, 3, v1
  v_add_u32 v116, s46, v116
  v_and_b32 v118, 15, v1
  v_lshrrev_b32 v119, 4, v1
  v_mul_u32_u24 v117, 544, v118
  v_lshl_add_u32 v117, v119, 4, v117
  v_add_u32 v117, s46, v117
  v_mov_b32 v188, 0
  v_mov_b32 v189, 0
  v_mov_b32 v190, 0
  v_mov_b32 v191, 0
  v_mov_b32 v192, 0
  v_mov_b32 v193, 0
  v_mov_b32 v194, 0
  v_mov_b32 v195, 0
  v_mov_b32 v196, 0
  v_mov_b32 v197, 0
  v_mov_b32 v198, 0
  v_mov_b32 v199, 0
  v_lshrrev_b32 v200, 1, v119
  v_lshlrev_b32 v200, 8, v200
  v_lshl_add_u32 v200, v118, 4, v200
  v_and_b32 v201, 1, v119
  v_lshl_add_u32 v200, v201, 3, v200
  v_add_u32 v200, s46, v200
  v_cmp_gt_u32 s[76:77], 2, v119
  v_lshlrev_b32 v202, 2, v118
  v_lshlrev_b32 v203, 3, v118
  v_cndmask_b32 v202, v202, v203, s[76:77]
  v_lshl_add_u32 v202, v119, 7, v202
  v_add_u32 v202, s46, v202
  v_cndmask_b32 v203, 64, 4, s[76:77]
  v_add_u32 v203, v202, v203
  v_lshlrev_b32 v204, 5, v118
  v_lshl_add_u32 v204, v119, 3, v204
  v_add_u32 v204, s46, v204
  v_lshlrev_b32 v208, 4, v1
  v_lshlrev_b32 v209, 3, v1
  v_add_u32 v209, 256, v209
  v_cmp_gt_u32 s[76:77], 32, v1
  s_nop 1
  v_cndmask_b32 v208, v209, v208, s[76:77]
  v_add_u32 v208, s46, v208
  v_lshlrev_b32 v209, 2, v1
  v_add_u32 v209, s46, v209
  v_add_u32 v209, 8704, v209
  v_lshlrev_b32 v214, 1, v1
  v_add_u32 v214, s46, v214
  v_and_b32 v210, 1, v1
  v_cmp_eq_u32 s[76:77], 1, v210
  v_mov_b32 v210, 0x01000504
  v_mov_b32 v211, 0x05040504
  v_cndmask_b32 v212, v210, v211, s[76:77]
  v_mov_b32 v213, 0x03020504
  v_sub_u32 v205, 63, v1
  v_lshlrev_b32 v205, 4, v205
  v_add_u32 v205, s46, v205
  v_lshrrev_b32 v240, 1, v118
  v_lshl_add_u32 v240, v119, 2, v240
  v_sub_u32 v240, 19, v240
  v_lshlrev_b32 v240, 2, v240
  v_mov_b32 v241, 4160
  v_cndmask_b32 v241, v241, 0, s[76:77]
  v_add3_u32 v235, v240, v241, s46
  v_add_u32 v232, 3072, v235
  v_add_u32 v233, 2048, v235
  v_add_u32 v234, 1024, v235
  v_lshlrev_b32 v236, 1, v118
  v_sub_u32 v236, v236, v119
  v_add_u32 v236, 3, v236
  v_mul_u32_u24 v236, 48, v236
  v_add_u32 v236, s45, v236
  v_lshrrev_b32 v242, 1, v119
  v_lshl_add_u32 v242, v118, 1, v242
  v_mul_u32_u24 v242, 48, v242
  v_and_b32 v243, 1, v119
  v_lshl_add_u32 v242, v243, 3, v242
  v_add_u32 v242, s45, v242
  v_mul_u32_u24 v243, 48, v1
  v_add_u32 v243, s45, v243
  v_lshlrev_b32 v237, 5, v118
  v_lshl_add_u32 v237, v119, 3, v237
  v_add_u32 v237, s46, v237
  v_lshlrev_b32 v239, 4, v1
  v_add_u32 v238, s46, v239
  v_mov_b32 v244, 0
  v_mov_b32 v245, 0
  v_mov_b32 v246, 0
  v_mov_b32 v247, 0
  s_mov_b64 exec, 0x3fffffff
  ds_write_b128 v243, v[244:247]
  s_mov_b64 exec, -1
  s_waitcnt lgkmcnt(0)
  s_mul_i32 s100, s100, 1664525
  s_add_u32 s100, s100, 1013904223
  s_or_b32 s100, s100, 0x100
  s_getreg_b32 s23, hwreg(HW_REG_XCC_ID, 0, 4)
  s_add_u32 s23, s23, 1
  s_xor_b32 s23, s23, s100
  s_lshl_b32 s22, s101, 2
  s_add_u32 s22, s22, 27266048
  s_cmp_eq_u32 s12, 5
  s_cselect_b32 s22, s22, 0x7f000000
  v_mov_b32 v2, s23
  v_mov_b32 v3, 0
  s_mov_b64 exec, 1
  buffer_store_dword v2, v3, s[36:39], s22 offen
  s_mov_b64 exec, -1
  v_bfe_u32 v4, v1, 2, 2
  v_mul_u32_u24 v5, 1344, v4
  v_lshrrev_b32 v4, 4, v1
  v_lshl_add_u32 v5, v4, 5, v5
  v_and_b32 v4, 3, v1
  v_lshl_add_u32 v5, v4, 3, v5
  s_mul_i32 s22, s13, 640
  s_add_u32 s22, s22, 142848
  v_add_u32 v5, s22, v5
  v_lshlrev_b32 v6, 4, v1
  v_add_u32 v7, 4096, v6
  s_mul_i32 s43, s101, 10240
  s_mul_i32 s22, s13, 5120
  s_add_u32 s43, s43, s22
  s_add_u32 s43, s43, 12582912
  s_cmp_lt_u32 s13, 2
  s_cselect_b32 s43, s43, 0x7f000000
  s_waitcnt vmcnt(1)
  v_lshlrev_b32 v54, 16, v54
  v_lshlrev_b32 v55, 16, v55
  s_mov_b32 s76, 0x3fb8aa3b
  s_mov_b32 s77, 0x32a57060
  v_mul_f32 v90, s76, v54
  v_readfirstlane_b32 s58, v55
  v_fma_f32 v91, v54, s76, -v90
  v_exp_f32 v90, v90
  v_fma_f32 v91, v54, s77, v91
  v_mul_f32 v91, 0x3f317218, v91
  v_lshlrev_b32 v56, 16, v48
  v_and_b32 v62, 0xffff0000, v48
  v_lshlrev_b32 v57, 16, v49
  v_and_b32 v63, 0xffff0000, v49
  v_lshlrev_b32 v58, 16, v50
  v_and_b32 v64, 0xffff0000, v50
  v_lshlrev_b32 v59, 16, v51
  v_and_b32 v65, 0xffff0000, v51
  v_lshlrev_b32 v60, 16, v52
  v_and_b32 v66, 0xffff0000, v52
  v_lshlrev_b32 v61, 16, v53
  v_and_b32 v67, 0xffff0000, v53
  v_fma_f32 v54, v90, v91, v90
  v_cvt_pk_bf16_f32 v54, v54, v54
  v_lshlrev_b32 v54, 16, v54
  s_mov_b32 s76, 0x01000100
  s_mov_b32 s77, 0x03020302
  v_mul_f32 v56, v54, v56
  v_mul_f32 v62, v54, v62
  v_mul_f32 v57, v54, v57
  v_mul_f32 v63, v54, v63
  v_mul_f32 v58, v54, v58
  v_mul_f32 v64, v54, v64
  v_mul_f32 v59, v54, v59
  v_mul_f32 v65, v54, v65
  v_mul_f32 v56, 0x3fb8aa3b, v56
  v_mul_f32 v62, 0x3fb8aa3b, v62
  v_mul_f32 v57, 0.15915494, v57
  v_mul_f32 v63, 0.15915494, v63
  v_mul_f32 v90, v61, v59
  v_mul_f32 v114, v67, v65
  v_mul_f32 v91, v61, v58
  v_mul_f32 v115, v67, v64
  v_fma_f32 v86, v60, v58, -v90
  v_fma_f32 v110, v66, v64, -v114
  v_fma_f32 v87, v60, v59, v91
  v_fma_f32 v111, v66, v65, v115
  v_exp_f32 v90, v56
  v_exp_f32 v114, v62
  v_fract_f32 v91, v57
  v_fract_f32 v115, v63
  v_cos_f32 v68, v91
  v_cos_f32 v92, v115
  v_sin_f32 v69, v91
  v_sin_f32 v93, v115
  v_mul_f32 v68, v90, v68
  v_mul_f32 v92, v114, v92
  v_mul_f32 v69, v90, v69
  v_mul_f32 v93, v114, v93
  v_mul_f32 v90, 0x43000000, v56
  v_mul_f32 v114, 0x43000000, v62
  v_mul_f32 v91, 0x43000000, v57
  v_mul_f32 v115, 0x43000000, v63
  v_exp_f32 v90, v90
  v_exp_f32 v114, v114
  v_fract_f32 v91, v91
  v_fract_f32 v115, v115
  v_cos_f32 v84, v91
  v_cos_f32 v108, v115
  v_sin_f32 v85, v91
  v_sin_f32 v109, v115
  v_mul_f32 v84, v90, v84
  v_mul_f32 v108, v114, v108
  v_mul_f32 v85, v90, v85
  v_mul_f32 v109, v114, v109
  v_mul_f32 v90, v69, v69
  v_mul_f32 v114, v93, v93
  v_add_f32 v91, v68, v68
  v_add_f32 v115, v92, v92
  v_fma_f32 v70, v68, v68, -v90
  v_fma_f32 v94, v92, v92, -v114
  v_mul_f32 v71, v91, v69
  v_mul_f32 v95, v115, v93
  v_mul_f32 v90, v71, v71
  v_mul_f32 v114, v95, v95
  v_add_f32 v91, v70, v70
  v_add_f32 v115, v94, v94
  v_fma_f32 v74, v70, v70, -v90
  v_fma_f32 v98, v94, v94, -v114
  v_mul_f32 v75, v91, v71
  v_mul_f32 v99, v115, v95
  v_mul_f32 v90, v75, v75
  v_mul_f32 v114, v99, v99
  v_add_f32 v91, v74, v74
  v_add_f32 v115, v98, v98
  v_fma_f32 v82, v74, v74, -v90
  v_fma_f32 v106, v98, v98, -v114
  v_mul_f32 v83, v91, v75
  v_mul_f32 v107, v115, v99
  v_mul_f32 v90, v87, v83
  v_mul_f32 v114, v111, v107
  v_mul_f32 v91, v87, v82
  v_mul_f32 v115, v111, v106
  v_fma_f32 v88, v86, v82, -v90
  v_fma_f32 v112, v110, v106, -v114
  v_fma_f32 v89, v86, v83, v91
  v_fma_f32 v113, v110, v107, v115
  v_cvt_pk_bf16_f32 v120, v86, -v87
  v_cvt_pk_bf16_f32 v121, v110, -v111
  v_mul_f32 v90, v89, v83
  v_mul_f32 v114, v113, v107
  ds_write_b64 v116, v[120:121] offset:0
  v_mul_f32 v91, v89, v82
  v_mul_f32 v115, v113, v106
  v_fma_f32 v86, v88, v82, -v90
  v_fma_f32 v110, v112, v106, -v114
  v_fma_f32 v87, v88, v83, v91
  v_fma_f32 v111, v112, v107, v115
  v_cvt_pk_bf16_f32 v122, v88, -v89
  v_cvt_pk_bf16_f32 v123, v112, -v113
  v_mul_f32 v90, v87, v83
  v_mul_f32 v114, v111, v107
  ds_write_b64 v116, v[122:123] offset:544
  v_mul_f32 v91, v87, v82
  v_mul_f32 v115, v111, v106
  v_fma_f32 v88, v86, v82, -v90
  v_fma_f32 v112, v110, v106, -v114
  v_fma_f32 v89, v86, v83, v91
  v_fma_f32 v113, v110, v107, v115
  v_cvt_pk_bf16_f32 v120, v86, -v87
  v_cvt_pk_bf16_f32 v121, v110, -v111
  v_mul_f32 v90, v89, v83
  v_mul_f32 v114, v113, v107
  ds_write_b64 v116, v[120:121] offset:1088
  v_mul_f32 v91, v89, v82
  v_mul_f32 v115, v113, v106
  v_fma_f32 v86, v88, v82, -v90
  v_fma_f32 v110, v112, v106, -v114
  v_fma_f32 v87, v88, v83, v91
  v_fma_f32 v111, v112, v107, v115
  v_cvt_pk_bf16_f32 v122, v88, -v89
  v_cvt_pk_bf16_f32 v123, v112, -v113
  v_mul_f32 v90, v87, v83
  v_mul_f32 v114, v111, v107
  ds_write_b64 v116, v[122:123] offset:1632
  v_mul_f32 v91, v87, v82
  v_mul_f32 v115, v111, v106
  v_fma_f32 v88, v86, v82, -v90
  v_fma_f32 v112, v110, v106, -v114
  v_fma_f32 v89, v86, v83, v91
  v_fma_f32 v113, v110, v107, v115
  v_cvt_pk_bf16_f32 v120, v86, -v87
  v_cvt_pk_bf16_f32 v121, v110, -v111
  v_mul_f32 v90, v89, v83
  v_mul_f32 v114, v113, v107
  ds_write_b64 v116, v[120:121] offset:2176
  v_mul_f32 v91, v89, v82
  v_mul_f32 v115, v113, v106
  v_fma_f32 v86, v88, v82, -v90
  v_fma_f32 v110, v112, v106, -v114
  v_fma_f32 v87, v88, v83, v91
  v_fma_f32 v111, v112, v107, v115
  v_cvt_pk_bf16_f32 v122, v88, -v89
  v_cvt_pk_bf16_f32 v123, v112, -v113
  v_mul_f32 v90, v87, v83
  v_mul_f32 v114, v111, v107
  ds_write_b64 v116, v[122:123] offset:2720
  v_mul_f32 v91, v87, v82
  v_mul_f32 v115, v111, v106
  v_fma_f32 v88, v86, v82, -v90
  v_fma_f32 v112, v110, v106, -v114
  v_fma_f32 v89, v86, v83, v91
  v_fma_f32 v113, v110, v107, v115
  v_cvt_pk_bf16_f32 v120, v86, -v87
  v_cvt_pk_bf16_f32 v121, v110, -v111
  v_mul_f32 v90, v89, v83
  v_mul_f32 v114, v113, v107
  ds_write_b64 v116, v[120:121] offset:3264
  v_mul_f32 v91, v89, v82
  v_mul_f32 v115, v113, v106
  v_fma_f32 v86, v88, v82, -v90
  v_fma_f32 v110, v112, v106, -v114
  v_fma_f32 v87, v88, v83, v91
  v_fma_f32 v111, v112, v107, v115
  v_cvt_pk_bf16_f32 v122, v88, -v89
  v_cvt_pk_bf16_f32 v123, v112, -v113
  v_mul_f32 v90, v87, v83
  v_mul_f32 v114, v111, v107
  ds_write_b64 v116, v[122:123] offset:3808
  v_mul_f32 v91, v87, v82
  v_mul_f32 v115, v111, v106
  v_fma_f32 v88, v86, v82, -v90
  v_fma_f32 v112, v110, v106, -v114
  v_fma_f32 v89, v86, v83, v91
  v_fma_f32 v113, v110, v107, v115
  s_barrier
  ds_read_b64_tr_b16 v[8:9], v5 offset:0
  ds_read_b64_tr_b16 v[10:11], v5 offset:5376
  ds_read_b64_tr_b16 v[12:13], v5 offset:128
  ds_read_b64_tr_b16 v[14:15], v5 offset:5504
  ds_read_b64_tr_b16 v[16:17], v5 offset:256
  ds_read_b64_tr_b16 v[18:19], v5 offset:5632
  ds_read_b64_tr_b16 v[20:21], v5 offset:384
  ds_read_b64_tr_b16 v[22:23], v5 offset:5760
  ds_read_b64_tr_b16 v[24:25], v5 offset:512
  ds_read_b64_tr_b16 v[26:27], v5 offset:5888
  v_cvt_pk_bf16_f32 v140, v86, -v87
  v_cvt_pk_bf16_f32 v141, v110, -v111
  v_mul_f32 v90, v89, v83
  v_mul_f32 v114, v113, v107
  v_mul_f32 v91, v89, v82
  v_mul_f32 v115, v113, v106
  v_fma_f32 v86, v88, v82, -v90
  v_fma_f32 v110, v112, v106, -v114
  v_fma_f32 v87, v88, v83, v91
  v_fma_f32 v111, v112, v107, v115
  v_cvt_pk_bf16_f32 v142, v88, -v89
  v_cvt_pk_bf16_f32 v143, v112, -v113
  v_mul_f32 v90, v87, v83
  v_mul_f32 v114, v111, v107
  v_mul_f32 v91, v87, v82
  s_barrier
  s_waitcnt lgkmcnt(0)
  buffer_store_dwordx4 v[8:11], v6, s[36:39], s43 offen offset:0 sc1
  v_mul_f32 v115, v111, v106
  v_fma_f32 v88, v86, v82, -v90
  v_fma_f32 v112, v110, v106, -v114
  v_fma_f32 v89, v86, v83, v91
  v_fma_f32 v113, v110, v107, v115
  v_cvt_pk_bf16_f32 v144, v86, -v87
  v_cvt_pk_bf16_f32 v145, v110, -v111
  v_mul_f32 v90, v89, v83
  v_mul_f32 v114, v113, v107
  v_mul_f32 v91, v89, v82
  v_mul_f32 v115, v113, v106
  v_fma_f32 v86, v88, v82, -v90
  buffer_store_dwordx4 v[12:15], v6, s[36:39], s43 offen offset:1024 sc1
  v_fma_f32 v110, v112, v106, -v114
  v_fma_f32 v87, v88, v83, v91
  v_fma_f32 v111, v112, v107, v115
  v_cvt_pk_bf16_f32 v146, v88, -v89
  v_cvt_pk_bf16_f32 v147, v112, -v113
  v_mul_f32 v90, v87, v83
  v_mul_f32 v114, v111, v107
  v_mul_f32 v91, v87, v82
  v_mul_f32 v115, v111, v106
  v_fma_f32 v88, v86, v82, -v90
  v_fma_f32 v112, v110, v106, -v114
  v_fma_f32 v89, v86, v83, v91
  buffer_store_dwordx4 v[16:19], v6, s[36:39], s43 offen offset:2048 sc1
  v_fma_f32 v113, v110, v107, v115
  v_cvt_pk_bf16_f32 v148, v86, -v87
  v_cvt_pk_bf16_f32 v149, v110, -v111
  v_mul_f32 v90, v89, v83
  v_mul_f32 v114, v113, v107
  v_mul_f32 v91, v89, v82
  v_mul_f32 v115, v113, v106
  v_fma_f32 v86, v88, v82, -v90
  v_fma_f32 v110, v112, v106, -v114
  v_fma_f32 v87, v88, v83, v91
  v_fma_f32 v111, v112, v107, v115
  v_cvt_pk_bf16_f32 v150, v88, -v89
  s_barrier
  buffer_store_dwordx4 v[20:23], v6, s[36:39], s43 offen offset:3072 sc1
  v_cvt_pk_bf16_f32 v151, v112, -v113
  v_mul_f32 v90, v87, v83
  v_mul_f32 v114, v111, v107
  v_mul_f32 v91, v87, v82
  v_mul_f32 v115, v111, v106
  v_fma_f32 v88, v86, v82, -v90
  v_fma_f32 v112, v110, v106, -v114
  v_fma_f32 v89, v86, v83, v91
  v_fma_f32 v113, v110, v107, v115
  v_cvt_pk_bf16_f32 v152, v86, -v87
  v_cvt_pk_bf16_f32 v153, v110, -v111
  v_cvt_pk_bf16_f32 v154, v88, -v89
  v_cvt_pk_bf16_f32 v155, v112, -v113
  v_mul_f32 v90, v71, v69
  v_mul_f32 v114, v95, v93
  v_mul_f32 v91, v71, v68
  v_mul_f32 v115, v95, v92
  v_fma_f32 v72, v70, v68, -v90
  buffer_store_dwordx4 v[24:27], v7, s[36:39], s43 offen offset:0 sc1
  v_fma_f32 v96, v94, v92, -v114
  v_fma_f32 v73, v70, v69, v91
  v_fma_f32 v97, v94, v93, v115
  v_mul_f32 v90, v75, v69
  v_mul_f32 v114, v99, v93
  v_mul_f32 v91, v75, v68
  v_mul_f32 v115, v99, v92
  v_fma_f32 v76, v74, v68, -v90
  v_fma_f32 v100, v98, v92, -v114
  v_fma_f32 v77, v74, v69, v91
  v_fma_f32 v101, v98, v93, v115
  v_mul_f32 v90, v75, v71
  v_mul_f32 v114, v99, v95
  v_mul_f32 v91, v75, v70
  v_mul_f32 v115, v99, v94
  v_fma_f32 v78, v74, v70, -v90
  v_fma_f32 v102, v98, v94, -v114
  v_fma_f32 v79, v74, v71, v91
  s_barrier
  v_fma_f32 v103, v98, v95, v115
  v_mul_f32 v90, v75, v73
  v_mul_f32 v114, v99, v97
  v_mul_f32 v91, v75, v72
  v_mul_f32 v115, v99, v96
  v_fma_f32 v80, v74, v72, -v90
  v_fma_f32 v104, v98, v96, -v114
  v_fma_f32 v81, v74, v73, v91
  v_fma_f32 v105, v98, v97, v115
  v_mov_b32 v120, 0x3f80
  v_mov_b32 v121, 0x3f80
  v_cvt_pk_bf16_f32 v156, v68, v69
  v_cvt_pk_bf16_f32 v157, v92, v93
  v_cvt_pk_bf16_f32 v158, v70, v71
  v_cvt_pk_bf16_f32 v159, v94, v95
  v_cvt_pk_bf16_f32 v160, v72, v73
  v_cvt_pk_bf16_f32 v161, v96, v97
  v_cvt_pk_bf16_f32 v162, v74, v75
  v_cvt_pk_bf16_f32 v163, v98, v99
  v_cvt_pk_bf16_f32 v164, v76, v77
  v_cvt_pk_bf16_f32 v165, v100, v101
  v_cvt_pk_bf16_f32 v166, v78, v79
  v_cvt_pk_bf16_f32 v167, v102, v103
  v_cvt_pk_bf16_f32 v168, v80, v81
  v_cvt_pk_bf16_f32 v169, v104, v105
  v_cvt_pk_bf16_f32 v170, v84, v85
  v_cvt_pk_bf16_f32 v171, v108, v109
  v_mul_f32 v90, v85, v69
  v_mul_f32 v114, v109, v93
  v_mul_f32 v91, v85, v68
  v_mul_f32 v115, v109, v92
  v_fma_f32 v86, v84, v68, -v90
  v_fma_f32 v110, v108, v92, -v114
  v_fma_f32 v87, v84, v69, v91
  v_fma_f32 v111, v108, v93, v115
  v_mul_f32 v90, v85, v71
  v_mul_f32 v114, v109, v95
  v_mul_f32 v91, v85, v70
  v_mul_f32 v115, v109, v94
  v_fma_f32 v88, v84, v70, -v90
  v_fma_f32 v112, v108, v94, -v114
  v_fma_f32 v89, v84, v71, v91
  v_fma_f32 v113, v108, v95, v115
  v_cvt_pk_bf16_f32 v172, v86, v87
  v_cvt_pk_bf16_f32 v173, v110, v111
  v_mul_f32 v90, v85, v73
  v_mul_f32 v114, v109, v97
  v_mul_f32 v91, v85, v72
  v_mul_f32 v115, v109, v96
  v_fma_f32 v86, v84, v72, -v90
  v_fma_f32 v110, v108, v96, -v114
  v_fma_f32 v87, v84, v73, v91
  v_fma_f32 v111, v108, v97, v115
  v_cvt_pk_bf16_f32 v174, v88, v89
  v_cvt_pk_bf16_f32 v175, v112, v113
  v_mul_f32 v90, v85, v75
  v_mul_f32 v114, v109, v99
  v_mul_f32 v91, v85, v74
  v_mul_f32 v115, v109, v98
  v_fma_f32 v88, v84, v74, -v90
  s_barrier
  s_cmp_eq_u32 s12, 6
  s_cbranch_scc1 K_B
  s_lshl_b32 s21, s14, 1
  s_add_u32 s21, s21, s13
  s_lshl_b32 s22, s3, 10
  s_lshl_b32 s23, s21, 2
  s_add_u32 s22, s22, s23
  s_add_u32 s22, s22, 27279360
  s_add_u32 s23, s22, 8192
  v_mov_b32 v252, s100
  v_mov_b32 v253, 0
  s_mov_b64 exec, 1
  s_waitcnt vmcnt(0)
  buffer_store_dword v252, v253, s[36:39], s22 offen
  buffer_store_dword v252, v253, s[36:39], s23 offen sc1
  s_mov_b64 exec, -1
K_B:
  v_fma_f32 v112, v108, v98, -v114
  v_fma_f32 v89, v84, v75, v91
  v_fma_f32 v113, v108, v99, v115
  v_cvt_pk_bf16_f32 v176, v86, v87
  v_cvt_pk_bf16_f32 v177, v110, v111
  v_mul_f32 v90, v85, v77
  v_mul_f32 v114, v109, v101
  v_mul_f32 v91, v85, v76
  v_mul_f32 v115, v109, v100
  v_fma_f32 v86, v84, v76, -v90
  v_fma_f32 v110, v108, v100, -v114
  v_fma_f32 v87, v84, v77, v91
  v_fma_f32 v111, v108, v101, v115
  v_cvt_pk_bf16_f32 v178, v88, v89
  v_cvt_pk_bf16_f32 v179, v112, v113
  v_mul_f32 v90, v85, v79
  v_mul_f32 v114, v109, v103
  v_mul_f32 v91, v85, v78
  v_mul_f32 v115, v109, v102
  v_fma_f32 v88, v84, v78, -v90
  v_fma_f32 v112, v108, v102, -v114
  v_fma_f32 v89, v84, v79, v91
  v_fma_f32 v113, v108, v103, v115
  v_cvt_pk_bf16_f32 v180, v86, v87
  v_cvt_pk_bf16_f32 v181, v110, v111
  v_mul_f32 v90, v85, v81
  v_mul_f32 v114, v109, v105
  v_mul_f32 v91, v85, v80
  v_mul_f32 v115, v109, v104
  v_fma_f32 v86, v84, v80, -v90
  v_fma_f32 v110, v108, v104, -v114
  v_fma_f32 v87, v84, v81, v91
  v_fma_f32 v111, v108, v105, v115
  v_cvt_pk_bf16_f32 v182, v88, v89
  v_cvt_pk_bf16_f32 v183, v112, v113
  v_mul_f32 v90, v85, v85
  v_mul_f32 v114, v109, v109
  v_add_f32 v91, v84, v84
  v_add_f32 v115, v108, v108
  v_fma_f32 v68, v84, v84, -v90
  v_fma_f32 v92, v108, v108, -v114
  v_mul_f32 v69, v91, v85
  v_mul_f32 v93, v115, v109
  v_cvt_pk_bf16_f32 v184, v86, v87
  v_cvt_pk_bf16_f32 v185, v110, v111
  v_mul_f32 v90, v69, v71
  v_mul_f32 v114, v93, v95
  v_mul_f32 v91, v69, v70
  v_mul_f32 v115, v93, v94
  v_fma_f32 v86, v68, v70, -v90
  v_fma_f32 v110, v92, v94, -v114
  v_fma_f32 v87, v68, v71, v91
  v_fma_f32 v111, v92, v95, v115
  v_cvt_pk_bf16_f32 v186, v68, v69
  v_cvt_pk_bf16_f32 v187, v92, v93
  v_mul_f32 v90, v69, v75
  v_mul_f32 v114, v93, v99
  v_mul_f32 v91, v69, v74
  v_mul_f32 v115, v93, v98
  s_barrier
  v_fma_f32 v88, v68, v74, -v90
  v_fma_f32 v112, v92, v98, -v114
  v_fma_f32 v89, v68, v75, v91
  v_fma_f32 v113, v92, v99, v115
  v_cvt_pk_bf16_f32 v248, v86, v87
  v_cvt_pk_bf16_f32 v249, v110, v111
  v_mul_f32 v90, v69, v79
  v_mul_f32 v114, v93, v103
  v_mul_f32 v91, v69, v78
  v_mul_f32 v115, v93, v102
  v_fma_f32 v86, v68, v78, -v90
  v_fma_f32 v110, v92, v102, -v114
  v_fma_f32 v87, v68, v79, v91
  v_fma_f32 v111, v92, v103, v115
  v_cvt_pk_bf16_f32 v250, v88, v89
  v_cvt_pk_bf16_f32 v251, v112, v113
  v_mul_f32 v90, v69, v85
  v_mul_f32 v114, v93, v109
  v_mul_f32 v91, v69, v84
  v_mul_f32 v115, v93, v108
  v_fma_f32 v72, v68, v84, -v90
  v_fma_f32 v96, v92, v108, -v114
  v_fma_f32 v73, v68, v85, v91
  v_fma_f32 v97, v92, v109, v115
  v_cvt_pk_bf16_f32 v2, v86, v87
  v_cvt_pk_bf16_f32 v3, v110, v111
  v_mul_f32 v90, v73, v71
  v_mul_f32 v114, v97, v95
  v_mul_f32 v91, v73, v70
  v_mul_f32 v115, v97, v94
  v_fma_f32 v86, v72, v70, -v90
  v_fma_f32 v110, v96, v94, -v114
  v_fma_f32 v87, v72, v71, v91
  v_fma_f32 v111, v96, v95, v115
  v_cvt_pk_bf16_f32 v4, v72, v73
  v_cvt_pk_bf16_f32 v5, v96, v97
  v_mul_f32 v90, v73, v75
  v_mul_f32 v114, v97, v99
  v_mul_f32 v91, v73, v74
  v_mul_f32 v115, v97, v98
  v_fma_f32 v88, v72, v74, -v90
  v_fma_f32 v112, v96, v98, -v114
  v_fma_f32 v89, v72, v75, v91
  v_fma_f32 v113, v96, v99, v115
  v_cvt_pk_bf16_f32 v6, v86, v87
  v_cvt_pk_bf16_f32 v7, v110, v111
  v_mul_f32 v90, v73, v79
  v_mul_f32 v114, v97, v103
  v_mul_f32 v91, v73, v78
  v_mul_f32 v115, v97, v102
  v_fma_f32 v86, v72, v78, -v90
  v_fma_f32 v110, v96, v102, -v114
  v_fma_f32 v87, v72, v79, v91
  v_fma_f32 v111, v96, v103, v115
  v_cvt_pk_bf16_f32 v8, v88, v89
  v_cvt_pk_bf16_f32 v9, v112, v113
  v_mul_f32 v90, v73, v85
  v_mul_f32 v114, v97, v109
  v_mul_f32 v91, v73, v84
  v_mul_f32 v115, v97, v108
  s_barrier
  v_fma_f32 v68, v72, v84, -v90
  v_fma_f32 v92, v96, v108, -v114
  v_fma_f32 v69, v72, v85, v91
  v_fma_f32 v93, v96, v109, v115
  v_cvt_pk_bf16_f32 v10, v86, v87
  v_cvt_pk_bf16_f32 v11, v110, v111
  v_mul_f32 v90, v69, v75
  v_mul_f32 v114, v93, v99
  v_mul_f32 v91, v69, v74
  v_mul_f32 v115, v93, v98
  v_fma_f32 v88, v68, v74, -v90
  v_fma_f32 v112, v92, v98, -v114
  v_fma_f32 v89, v68, v75, v91
  v_fma_f32 v113, v92, v99, v115
  v_cvt_pk_bf16_f32 v12, v68, v69
  v_cvt_pk_bf16_f32 v13, v92, v93
  v_mul_f32 v90, v69, v85
  v_mul_f32 v114, v93, v109
  v_mul_f32 v91, v69, v84
  v_mul_f32 v115, v93, v108
  v_fma_f32 v72, v68, v84, -v90
  v_fma_f32 v96, v92, v108, -v114
  v_fma_f32 v73, v68, v85, v91
  v_fma_f32 v97, v92, v109, v115
  v_cvt_pk_bf16_f32 v14, v88, v89
  v_cvt_pk_bf16_f32 v15, v112, v113
  v_mul_f32 v90, v73, v75
  v_mul_f32 v114, v97, v99
  v_mul_f32 v91, v73, v74
  v_mul_f32 v115, v97, v98
  v_fma_f32 v88, v72, v74, -v90
  v_fma_f32 v112, v96, v98, -v114
  v_fma_f32 v89, v72, v75, v91
  v_fma_f32 v113, v96, v99, v115
  v_cvt_pk_bf16_f32 v16, v72, v73
  v_cvt_pk_bf16_f32 v17, v96, v97
  v_mul_f32 v90, v73, v85
  v_mul_f32 v114, v97, v109
  v_mul_f32 v91, v73, v84
  v_mul_f32 v115, v97, v108
  v_fma_f32 v68, v72, v84, -v90
  v_fma_f32 v92, v96, v108, -v114
  v_fma_f32 v69, v72, v85, v91
  v_fma_f32 v93, v96, v109, v115
  v_cvt_pk_bf16_f32 v18, v88, v89
  v_cvt_pk_bf16_f32 v19, v112, v113
  v_mul_f32 v90, v69, v75
  v_mul_f32 v114, v93, v99
  v_mul_f32 v91, v69, v74
  v_mul_f32 v115, v93, v98
  v_fma_f32 v88, v68, v74, -v90
  v_fma_f32 v112, v92, v98, -v114
  v_fma_f32 v89, v68, v75, v91
  v_fma_f32 v113, v92, v99, v115
  v_cvt_pk_bf16_f32 v20, v68, v69
  v_cvt_pk_bf16_f32 v21, v92, v93
  v_mul_f32 v90, v69, v85
  v_mul_f32 v114, v93, v109
  v_mul_f32 v91, v69, v84
  v_mul_f32 v115, v93, v108
  s_barrier
  v_fma_f32 v72, v68, v84, -v90
  v_fma_f32 v96, v92, v108, -v114
  v_fma_f32 v73, v68, v85, v91
  v_fma_f32 v97, v92, v109, v115
  v_cvt_pk_bf16_f32 v22, v88, v89
  v_cvt_pk_bf16_f32 v23, v112, v113
  v_mul_f32 v90, v73, v75
  v_mul_f32 v114, v97, v99
  v_mul_f32 v91, v73, v74
  v_mul_f32 v115, v97, v98
  v_fma_f32 v88, v72, v74, -v90
  v_fma_f32 v112, v96, v98, -v114
  v_fma_f32 v89, v72, v75, v91
  v_fma_f32 v113, v96, v99, v115
  v_cvt_pk_bf16_f32 v24, v72, v73
  v_cvt_pk_bf16_f32 v25, v96, v97
  v_mul_f32 v90, v73, v85
  v_mul_f32 v114, v97, v109
  v_mul_f32 v91, v73, v84
  v_mul_f32 v115, v97, v108
  v_fma_f32 v68, v72, v84, -v90
  v_fma_f32 v92, v96, v108, -v114
  v_fma_f32 v69, v72, v85, v91
  v_fma_f32 v93, v96, v109, v115
  v_cvt_pk_bf16_f32 v26, v88, v89
  v_cvt_pk_bf16_f32 v27, v112, v113
  v_mul_f32 v90, v69, v85
  v_mul_f32 v114, v93, v109
  v_mul_f32 v91, v69, v84
  v_mul_f32 v115, v93, v108
  v_fma_f32 v72, v68, v84, -v90
  v_fma_f32 v96, v92, v108, -v114
  v_fma_f32 v73, v68, v85, v91
  v_fma_f32 v97, v92, v109, v115
  v_cvt_pk_bf16_f32 v28, v68, v69
  v_cvt_pk_bf16_f32 v29, v92, v93
  v_mul_f32 v90, v73, v85
  v_mul_f32 v114, v97, v109
  v_mul_f32 v91, v73, v84
  v_mul_f32 v115, v97, v108
  v_fma_f32 v68, v72, v84, -v90
  v_fma_f32 v92, v96, v108, -v114
  v_fma_f32 v69, v72, v85, v91
  v_fma_f32 v93, v96, v109, v115
  v_cvt_pk_bf16_f32 v30, v72, v73
  v_cvt_pk_bf16_f32 v31, v96, v97
  v_mul_f32 v90, v69, v85
  v_mul_f32 v114, v93, v109
  v_mul_f32 v91, v69, v84
  v_mul_f32 v115, v93, v108
  v_fma_f32 v72, v68, v84, -v90
  v_fma_f32 v96, v92, v108, -v114
  v_fma_f32 v73, v68, v85, v91
  v_fma_f32 v97, v92, v109, v115
  v_cvt_pk_bf16_f32 v32, v68, v69
  v_cvt_pk_bf16_f32 v33, v92, v93
  v_mul_f32 v90, v73, v85
  v_mul_f32 v114, v97, v109
  v_mul_f32 v91, v73, v84
  v_mul_f32 v115, v97, v108
  s_barrier
  v_fma_f32 v68, v72, v84, -v90
  v_fma_f32 v92, v96, v108, -v114
  v_fma_f32 v69, v72, v85, v91
  v_fma_f32 v93, v96, v109, v115
  v_cvt_pk_bf16_f32 v34, v72, v73
  v_cvt_pk_bf16_f32 v35, v96, v97
  v_mul_f32 v90, v69, v85
  v_mul_f32 v114, v93, v109
  v_mul_f32 v91, v69, v84
  v_mul_f32 v115, v93, v108
  v_fma_f32 v72, v68, v84, -v90
  v_fma_f32 v96, v92, v108, -v114
  v_fma_f32 v73, v68, v85, v91
  v_fma_f32 v97, v92, v109, v115
  v_cvt_pk_bf16_f32 v36, v68, v69
  v_cvt_pk_bf16_f32 v37, v92, v93
  v_mul_f32 v90, v73, v85
  v_mul_f32 v114, v97, v109
  v_mul_f32 v91, v73, v84
  v_mul_f32 v115, v97, v108
  v_fma_f32 v68, v72, v84, -v90
  v_fma_f32 v92, v96, v108, -v114
  v_fma_f32 v69, v72, v85, v91
  v_fma_f32 v93, v96, v109, v115
  v_cvt_pk_bf16_f32 v38, v72, v73
  v_cvt_pk_bf16_f32 v39, v96, v97
  v_mul_f32 v90, v69, v85
  v_mul_f32 v114, v93, v109
  v_mul_f32 v91, v69, v84
  v_mul_f32 v115, v93, v108
  v_fma_f32 v72, v68, v84, -v90
  v_fma_f32 v96, v92, v108, -v114
  v_fma_f32 v73, v68, v85, v91
  v_fma_f32 v97, v92, v109, v115
  v_cvt_pk_bf16_f32 v40, v68, v69
  v_cvt_pk_bf16_f32 v41, v92, v93
  v_mul_f32 v90, v73, v85
  v_mul_f32 v114, v97, v109
  v_mul_f32 v91, v73, v84
  v_mul_f32 v115, v97, v108
  v_fma_f32 v68, v72, v84, -v90
  v_fma_f32 v92, v96, v108, -v114
  v_fma_f32 v69, v72, v85, v91
  v_fma_f32 v93, v96, v109, v115
  v_cvt_pk_bf16_f32 v42, v72, v73
  v_cvt_pk_bf16_f32 v43, v96, v97
  v_cvt_pk_bf16_f32 v44, v68, v69
  v_cvt_pk_bf16_f32 v45, v92, v93
  s_barrier
  ds_write_b64 v116, v[140:141] offset:4352
  ds_write_b64 v116, v[142:143] offset:4896
  ds_write_b64 v116, v[144:145] offset:5440
  ds_write_b64 v116, v[146:147] offset:5984
  ds_write_b64 v116, v[148:149] offset:6528
  ds_write_b64 v116, v[150:151] offset:7072
  ds_write_b64 v116, v[152:153] offset:7616
  ds_write_b64 v116, v[154:155] offset:8160
  ds_read_b128 v[124:127], v117 offset:0
  ds_read_b128 v[128:131], v117 offset:64
  ds_read_b128 v[132:135], v117 offset:128
  ds_read_b128 v[136:139], v117 offset:192
  ds_read_b128 v[140:143], v117 offset:256
  ds_read_b128 v[144:147], v117 offset:320
  ds_read_b128 v[148:151], v117 offset:384
  ds_read_b128 v[152:155], v117 offset:448
  ds_write_b64 v116, v[120:121]
  ds_write_b64 v116, v[156:157] offset:544
  ds_write_b64 v116, v[158:159] offset:1088
  ds_write_b64 v116, v[160:161] offset:1632
  ds_write_b64 v116, v[162:163] offset:2176
  ds_write_b64 v116, v[164:165] offset:2720
  ds_write_b64 v116, v[166:167] offset:3264
  ds_write_b64 v116, v[168:169] offset:3808
  ds_write_b64 v116, v[170:171] offset:4352
  ds_write_b64 v116, v[172:173] offset:4896
  ds_write_b64 v116, v[174:175] offset:5440
  ds_write_b64 v116, v[176:177] offset:5984
  ds_write_b64 v116, v[178:179] offset:6528
  ds_write_b64 v116, v[180:181] offset:7072
  ds_write_b64 v116, v[182:183] offset:7616
  ds_write_b64 v116, v[184:185] offset:8160
  ds_read_b128 v[48:51], v117 offset:0
  ds_read_b128 v[52:55], v117 offset:64
  ds_read_b128 v[56:59], v117 offset:128
  ds_read_b128 v[60:63], v117 offset:192
  ds_read_b128 v[64:67], v117 offset:256
  ds_read_b128 v[68:71], v117 offset:320
  ds_read_b128 v[72:75], v117 offset:384
  ds_read_b128 v[76:79], v117 offset:448
  ds_write_b64 v116, v[186:187] offset:0
  ds_write_b64 v116, v[248:249] offset:544
  ds_write_b64 v116, v[250:251] offset:1088
  ds_write_b64 v116, v[2:3] offset:1632
  ds_write_b64 v116, v[4:5] offset:2176
  ds_write_b64 v116, v[6:7] offset:2720
  ds_write_b64 v116, v[8:9] offset:3264
  ds_write_b64 v116, v[10:11] offset:3808
  ds_write_b64 v116, v[12:13] offset:4352
  ds_write_b64 v116, v[14:15] offset:4896
  ds_write_b64 v116, v[16:17] offset:5440
  ds_write_b64 v116, v[18:19] offset:5984
  ds_write_b64 v116, v[20:21] offset:6528
  ds_write_b64 v116, v[22:23] offset:7072
  ds_write_b64 v116, v[24:25] offset:7616
  ds_write_b64 v116, v[26:27] offset:8160
  ds_read_b128 v[80:83], v117 offset:0
  ds_read_b128 v[84:87], v117 offset:64
  ds_read_b128 v[88:91], v117 offset:128
  ds_read_b128 v[92:95], v117 offset:192
  ds_read_b128 v[96:99], v117 offset:256
  ds_read_b128 v[100:103], v117 offset:320
  ds_read_b128 v[104:107], v117 offset:384
  ds_read_b128 v[108:111], v117 offset:448
  s_waitcnt lgkmcnt(15)
  v_mfma_f32_16x16x32_bf16 v[188:191], v[48:51], v[124:127], v[188:191]
  v_mfma_f32_16x16x32_bf16 v[188:191], v[52:55], v[128:131], v[188:191]
  v_mfma_f32_16x16x32_bf16 v[188:191], v[56:59], v[132:135], v[188:191]
  v_mfma_f32_16x16x32_bf16 v[188:191], v[60:63], v[136:139], v[188:191]
  v_mfma_f32_16x16x32_bf16 v[188:191], v[64:67], v[140:143], v[188:191]
  v_mfma_f32_16x16x32_bf16 v[188:191], v[68:71], v[144:147], v[188:191]
  v_mfma_f32_16x16x32_bf16 v[188:191], v[72:75], v[148:151], v[188:191]
  v_mfma_f32_16x16x32_bf16 v[188:191], v[76:79], v[152:155], v[188:191]
  ds_write_b64 v116, v[28:29] offset:0
  ds_write_b64 v116, v[30:31] offset:544
  ds_write_b64 v116, v[32:33] offset:1088
  ds_write_b64 v116, v[34:35] offset:1632
  ds_write_b64 v116, v[36:37] offset:2176
  ds_write_b64 v116, v[38:39] offset:2720
  ds_write_b64 v116, v[40:41] offset:3264
  ds_write_b64 v116, v[42:43] offset:3808
  ds_write_b64 v116, v[44:45] offset:4352
  ds_read_b128 v[156:159], v117 offset:0
  ds_read_b128 v[160:163], v117 offset:64
  ds_read_b128 v[164:167], v117 offset:128
  ds_read_b128 v[168:171], v117 offset:192
  ds_read_b128 v[172:175], v117 offset:256
  ds_read_b128 v[176:179], v117 offset:320
  ds_read_b128 v[180:183], v117 offset:384
  ds_read_b128 v[184:187], v117 offset:448
  s_waitcnt lgkmcnt(15)
  v_mfma_f32_16x16x32_bf16 v[192:195], v[80:83], v[124:127], v[192:195]
  v_mfma_f32_16x16x32_bf16 v[192:195], v[84:87], v[128:131], v[192:195]
  v_mfma_f32_16x16x32_bf16 v[192:195], v[88:91], v[132:135], v[192:195]
  v_mfma_f32_16x16x32_bf16 v[192:195], v[92:95], v[136:139], v[192:195]
  v_mfma_f32_16x16x32_bf16 v[192:195], v[96:99], v[140:143], v[192:195]
  v_mfma_f32_16x16x32_bf16 v[192:195], v[100:103], v[144:147], v[192:195]
  v_mfma_f32_16x16x32_bf16 v[192:195], v[104:107], v[148:151], v[192:195]
  v_mfma_f32_16x16x32_bf16 v[192:195], v[108:111], v[152:155], v[192:195]
  s_waitcnt lgkmcnt(0)
  v_mfma_f32_16x16x32_bf16 v[196:199], v[124:127], v[156:159], v[196:199]
  v_mfma_f32_16x16x32_bf16 v[196:199], v[128:131], v[160:163], v[196:199]
  v_mfma_f32_16x16x32_bf16 v[196:199], v[132:135], v[164:167], v[196:199]
  v_mfma_f32_16x16x32_bf16 v[196:199], v[136:139], v[168:171], v[196:199]
  v_mfma_f32_16x16x32_bf16 v[196:199], v[140:143], v[172:175], v[196:199]
  v_mfma_f32_16x16x32_bf16 v[196:199], v[144:147], v[176:179], v[196:199]
  v_mfma_f32_16x16x32_bf16 v[196:199], v[148:151], v[180:183], v[196:199]
  v_mfma_f32_16x16x32_bf16 v[196:199], v[152:155], v[184:187], v[196:199]
  v_cvt_pk_bf16_f32 v56, v188, v189
  v_cvt_pk_bf16_f32 v57, v190, v191
  v_cvt_pk_bf16_f32 v58, v192, v193
  v_cvt_pk_bf16_f32 v59, v194, v195
  ds_write_b64 v200, v[56:57] offset:8704
  ds_write_b32 v202, v58 offset:9216
  ds_write_b32 v203, v59 offset:9216
  s_nop 0
  v_cvt_pk_bf16_f32 v60, v196, v197
  v_cvt_pk_bf16_f32 v61, v198, v199
  ds_write_b64 v204, v[60:61] offset:9728
  ds_read_b64 v[68:69], v208 offset:8704
  ds_read_b64 v[70:71], v208 offset:8712
  ds_read2_b32 v[72:73], v209 offset0:192 offset1:193
  ds_read_u16 v74, v214 offset:9728
  ds_read_u16 v75, v214 offset:9730
  ds_read_u16 v76, v214 offset:9856
  ds_read_u16 v77, v214 offset:9858
  s_mov_b64 exec, 3
  ds_write_b128 v238, v[244:247] offset:4096
  ds_write_b128 v238, v[244:247] offset:8256
  s_mov_b64 exec, -1
  s_waitcnt lgkmcnt(7)
  v_alignbit_b32 v216, v71, v71, 16
  v_alignbit_b32 v217, v70, v70, 16
  v_alignbit_b32 v218, v69, v69, 16
  v_alignbit_b32 v219, v68, v68, 16
  s_mov_b32 exec_lo, 0
  v_perm_b32 v216, v70, v69, v213
  v_perm_b32 v217, v69, v69, s76
  v_perm_b32 v218, v69, v68, v213
  v_perm_b32 v219, v68, v68, s76
  s_mov_b32 exec_lo, -1
  s_waitcnt lgkmcnt(6)
  v_perm_b32 v220, v73, v73, s76
  v_perm_b32 v221, v72, v72, s77
  v_alignbit_b32 v222, v72, v72, 16
  v_perm_b32 v223, v72, v72, s76
  s_waitcnt lgkmcnt(4)
  v_perm_b32 v224, v75, v75, s76
  v_perm_b32 v225, v75, v74, v212
  v_perm_b32 v226, v74, v74, s76
  v_mov_b32 v227, v226
  s_waitcnt lgkmcnt(2)
  v_perm_b32 v228, v77, v77, s76
  v_perm_b32 v229, v77, v76, v212
  v_perm_b32 v230, v76, v76, s76
  v_mov_b32 v231, v230
  ds_write_b128 v205, v[216:219] offset:3072
  ds_write_b128 v205, v[220:223] offset:2048
  ds_write_b128 v205, v[224:227] offset:1024
  ds_write_b128 v205, v[228:231] offset:0
  ds_read_b32 v80, v205 offset:3088
  ds_read_b32 v81, v205 offset:2064
  ds_read_b32 v82, v205 offset:1040
  ds_read_b32 v83, v205 offset:16
  v_alignbit_b32 v84, v217, v216, 16
  v_alignbit_b32 v85, v218, v217, 16
  v_alignbit_b32 v86, v219, v218, 16
  s_waitcnt lgkmcnt(3)
  v_alignbit_b32 v87, v80, v219, 16
  ds_write_b128 v205, v[84:87] offset:7232
  v_alignbit_b32 v88, v221, v220, 16
  v_alignbit_b32 v89, v222, v221, 16
  v_alignbit_b32 v90, v223, v222, 16
  s_waitcnt lgkmcnt(3)
  v_alignbit_b32 v91, v81, v223, 16
  ds_write_b128 v205, v[88:91] offset:6208
  v_alignbit_b32 v92, v225, v224, 16
  v_alignbit_b32 v93, v226, v225, 16
  v_alignbit_b32 v94, v227, v226, 16
  s_waitcnt lgkmcnt(3)
  v_alignbit_b32 v95, v82, v227, 16
  ds_write_b128 v205, v[92:95] offset:5184
  v_alignbit_b32 v96, v229, v228, 16
  v_alignbit_b32 v97, v230, v229, 16
  v_alignbit_b32 v98, v231, v230, 16
  s_waitcnt lgkmcnt(3)
  v_alignbit_b32 v99, v83, v231, 16
  ds_write_b128 v205, v[96:99] offset:4160
  v_mov_b32 v252, 163332
SL_21:
  ds_read_b32 v253, v252
  s_waitcnt lgkmcnt(0)
  v_cmp_ne_u32 vcc, s100, v253
  s_cbranch_vccz SO_22
  s_sleep 1
  s_add_u32 s79, s79, 1
  s_cmp_lt_u32 s79, 200000
  s_cbranch_scc1 SL_21
SO_22:
  s_lshl_b32 s22, s13, 2
  s_add_u32 s22, s22, 163336
  v_mov_b32 v252, s22
SG_23:
  ds_read_b32 v253, v252
  s_waitcnt lgkmcnt(0)
  v_cmp_gt_u32 vcc, 2, v253
  s_cbranch_vccz SO_24
  s_sleep 1
  s_add_u32 s79, s79, 1
  s_cmp_lt_u32 s79, 200000
  s_cbranch_scc1 SG_23
SO_24:
  s_setprio 1
  ds_read2_b32 v[48:49], v232 offset0:240 offset1:241
  ds_read2_b32 v[50:51], v232 offset0:242 offset1:243
  ds_read_b128 v[52:55], v236 offset:1344
  ds_read2_b32 v[56:57], v232 offset0:112 offset1:113
  ds_read2_b32 v[58:59], v232 offset0:114 offset1:115
  ds_read_b128 v[60:63], v236 offset:2880
  ds_read2_b32 v[64:65], v233 offset0:240 offset1:241
  ds_read2_b32 v[66:67], v233 offset0:242 offset1:243
  ds_read_b128 v[68:71], v236 offset:4416
  ds_read2_b32 v[72:73], v233 offset0:112 offset1:113
  ds_read2_b32 v[74:75], v233 offset0:114 offset1:115
  ds_read_b128 v[76:79], v236 offset:5952
  ds_read2_b32 v[80:81], v234 offset0:240 offset1:241
  ds_read2_b32 v[82:83], v234 offset0:242 offset1:243
  ds_read_b128 v[84:87], v236 offset:7488
  ds_read2_b32 v[88:89], v234 offset0:112 offset1:113
  ds_read2_b32 v[90:91], v234 offset0:114 offset1:115
  ds_read_b128 v[92:95], v236 offset:9024
  ds_read2_b32 v[96:97], v235 offset0:240 offset1:241
  ds_read2_b32 v[98:99], v235 offset0:242 offset1:243
  ds_read_b128 v[100:103], v236 offset:10560
  ds_read2_b32 v[104:105], v235 offset0:112 offset1:113
  ds_read2_b32 v[106:107], v235 offset0:114 offset1:115
  ds_read_b128 v[108:111], v236 offset:12096
  s_waitcnt lgkmcnt(15)
  v_mfma_f32_16x16x32_bf16 v[16:19], v[48:51], v[52:55], 0
  v_mfma_f32_16x16x32_bf16 v[20:23], v[48:51], v[60:63], 0
  v_mfma_f32_16x16x32_bf16 v[20:23], v[56:59], v[52:55], v[20:23]
  v_mfma_f32_16x16x32_bf16 v[24:27], v[56:59], v[60:63], 0
  v_mfma_f32_16x16x32_bf16 v[24:27], v[48:51], v[68:71], v[24:27]
  v_mfma_f32_16x16x32_bf16 v[28:31], v[56:59], v[68:71], 0
  v_mfma_f32_16x16x32_bf16 v[24:27], v[64:67], v[52:55], v[24:27]
  v_mfma_f32_16x16x32_bf16 v[28:31], v[64:67], v[60:63], v[28:31]
  v_mfma_f32_16x16x32_bf16 v[32:35], v[64:67], v[68:71], 0
  ds_read2_b32 v[112:113], v232 offset0:224 offset1:225
  s_waitcnt lgkmcnt(13)
  v_mfma_f32_16x16x32_bf16 v[28:31], v[48:51], v[76:79], v[28:31]
  ds_read2_b32 v[114:115], v232 offset0:226 offset1:227
  v_mfma_f32_16x16x32_bf16 v[32:35], v[56:59], v[76:79], v[32:35]
  ds_read_b128 v[116:119], v236 offset:1152
  v_mfma_f32_16x16x32_bf16 v[36:39], v[64:67], v[76:79], 0
  ds_read2_b32 v[120:121], v232 offset0:96 offset1:97
  v_mfma_f32_16x16x32_bf16 v[28:31], v[72:75], v[52:55], v[28:31]
  ds_read2_b32 v[122:123], v232 offset0:98 offset1:99
  v_mfma_f32_16x16x32_bf16 v[32:35], v[72:75], v[60:63], v[32:35]
  ds_read_b128 v[124:127], v236 offset:2688
  v_mfma_f32_16x16x32_bf16 v[36:39], v[72:75], v[68:71], v[36:39]
  ds_read2_b32 v[128:129], v233 offset0:224 offset1:225
  v_mfma_f32_16x16x32_bf16 v[40:43], v[72:75], v[76:79], 0
  ds_read2_b32 v[130:131], v233 offset0:226 offset1:227
  s_waitcnt lgkmcnt(15)
  v_mfma_f32_16x16x32_bf16 v[32:35], v[48:51], v[84:87], v[32:35]
  ds_read_b128 v[132:135], v236 offset:4224
  v_mfma_f32_16x16x32_bf16 v[36:39], v[56:59], v[84:87], v[36:39]
  ds_read2_b32 v[136:137], v233 offset0:96 offset1:97
  v_mfma_f32_16x16x32_bf16 v[40:43], v[64:67], v[84:87], v[40:43]
  ds_read2_b32 v[138:139], v233 offset0:98 offset1:99
  v_mfma_f32_16x16x32_bf16 v[44:47], v[72:75], v[84:87], 0
  ds_read_b128 v[140:143], v236 offset:5760
  v_mfma_f32_16x16x32_bf16 v[32:35], v[80:83], v[52:55], v[32:35]
  ds_read2_b32 v[144:145], v234 offset0:224 offset1:225
  v_mfma_f32_16x16x32_bf16 v[36:39], v[80:83], v[60:63], v[36:39]
  ds_read2_b32 v[146:147], v234 offset0:226 offset1:227
  v_mfma_f32_16x16x32_bf16 v[40:43], v[80:83], v[68:71], v[40:43]
  ds_read_b128 v[148:151], v236 offset:7296
  v_mfma_f32_16x16x32_bf16 v[44:47], v[80:83], v[76:79], v[44:47]
  ds_read2_b32 v[152:153], v234 offset0:96 offset1:97
  s_waitcnt lgkmcnt(15)
  v_mfma_f32_16x16x32_bf16 v[36:39], v[48:51], v[92:95], v[36:39]
  ds_read2_b32 v[154:155], v234 offset0:98 offset1:99
  v_mfma_f32_16x16x32_bf16 v[40:43], v[56:59], v[92:95], v[40:43]
  ds_read_b128 v[156:159], v236 offset:8832
  v_mfma_f32_16x16x32_bf16 v[44:47], v[64:67], v[92:95], v[44:47]
  ds_read2_b32 v[160:161], v235 offset0:224 offset1:225
  v_mfma_f32_16x16x32_bf16 v[36:39], v[88:91], v[52:55], v[36:39]
  ds_read2_b32 v[162:163], v235 offset0:226 offset1:227
  v_mfma_f32_16x16x32_bf16 v[40:43], v[88:91], v[60:63], v[40:43]
  ds_read_b128 v[164:167], v236 offset:10368
  v_mfma_f32_16x16x32_bf16 v[44:47], v[88:91], v[68:71], v[44:47]
  ds_read2_b32 v[168:169], v235 offset0:96 offset1:97
  v_mfma_f32_16x16x32_bf16 v[40:43], v[48:51], v[100:103], v[40:43]
  ds_read2_b32 v[170:171], v235 offset0:98 offset1:99
  v_mfma_f32_16x16x32_bf16 v[44:47], v[56:59], v[100:103], v[44:47]
  ds_read_b128 v[172:175], v236 offset:11904
  v_mfma_f32_16x16x32_bf16 v[40:43], v[96:99], v[52:55], v[40:43]
  v_mfma_f32_16x16x32_bf16 v[44:47], v[96:99], v[60:63], v[44:47]
  v_mfma_f32_16x16x32_bf16 v[44:47], v[48:51], v[108:111], v[44:47]
  v_mfma_f32_16x16x32_bf16 v[44:47], v[104:107], v[52:55], v[44:47]
  s_waitcnt lgkmcnt(0)
  v_mfma_f32_16x16x32_bf16 v[16:19], v[112:115], v[116:119], v[16:19]
  ds_read2_b32 v[48:49], v232 offset0:208 offset1:209
  v_mfma_f32_16x16x32_bf16 v[20:23], v[112:115], v[124:127], v[20:23]
  ds_read2_b32 v[50:51], v232 offset0:210 offset1:211
  v_mfma_f32_16x16x32_bf16 v[20:23], v[120:123], v[116:119], v[20:23]
  ds_read_b128 v[52:55], v236 offset:960
  v_mfma_f32_16x16x32_bf16 v[24:27], v[120:123], v[124:127], v[24:27]
  ds_read2_b32 v[56:57], v232 offset0:80 offset1:81
  v_mfma_f32_16x16x32_bf16 v[24:27], v[112:115], v[132:135], v[24:27]
  ds_read2_b32 v[58:59], v232 offset0:82 offset1:83
  v_mfma_f32_16x16x32_bf16 v[28:31], v[120:123], v[132:135], v[28:31]
  ds_read_b128 v[60:63], v236 offset:2496
  v_mfma_f32_16x16x32_bf16 v[24:27], v[128:131], v[116:119], v[24:27]
  ds_read2_b32 v[64:65], v233 offset0:208 offset1:209
  v_mfma_f32_16x16x32_bf16 v[28:31], v[128:131], v[124:127], v[28:31]
  ds_read2_b32 v[66:67], v233 offset0:210 offset1:211
  v_mfma_f32_16x16x32_bf16 v[32:35], v[128:131], v[132:135], v[32:35]
  ds_read_b128 v[68:71], v236 offset:4032
  v_mfma_f32_16x16x32_bf16 v[28:31], v[112:115], v[140:143], v[28:31]
  ds_read2_b32 v[72:73], v233 offset0:80 offset1:81
  v_mfma_f32_16x16x32_bf16 v[32:35], v[120:123], v[140:143], v[32:35]
  ds_read2_b32 v[74:75], v233 offset0:82 offset1:83
  v_mfma_f32_16x16x32_bf16 v[36:39], v[128:131], v[140:143], v[36:39]
  ds_read_b128 v[76:79], v236 offset:5568
  v_mfma_f32_16x16x32_bf16 v[28:31], v[136:139], v[116:119], v[28:31]
  ds_read2_b32 v[80:81], v234 offset0:208 offset1:209
  v_mfma_f32_16x16x32_bf16 v[32:35], v[136:139], v[124:127], v[32:35]
  ds_read2_b32 v[82:83], v234 offset0:210 offset1:211
  v_mfma_f32_16x16x32_bf16 v[36:39], v[136:139], v[132:135], v[36:39]
  ds_read_b128 v[84:87], v236 offset:7104
  v_mfma_f32_16x16x32_bf16 v[40:43], v[136:139], v[140:143], v[40:43]
  ds_read2_b32 v[88:89], v234 offset0:80 offset1:81
  v_mfma_f32_16x16x32_bf16 v[32:35], v[112:115], v[148:151], v[32:35]
  ds_read2_b32 v[90:91], v234 offset0:82 offset1:83
  v_mfma_f32_16x16x32_bf16 v[36:39], v[120:123], v[148:151], v[36:39]
  ds_read_b128 v[92:95], v236 offset:8640
  v_mfma_f32_16x16x32_bf16 v[40:43], v[128:131], v[148:151], v[40:43]
  ds_read2_b32 v[96:97], v235 offset0:208 offset1:209
  v_mfma_f32_16x16x32_bf16 v[44:47], v[136:139], v[148:151], v[44:47]
  ds_read2_b32 v[98:99], v235 offset0:210 offset1:211
  v_mfma_f32_16x16x32_bf16 v[32:35], v[144:147], v[116:119], v[32:35]
  ds_read_b128 v[100:103], v236 offset:10176
  v_mfma_f32_16x16x32_bf16 v[36:39], v[144:147], v[124:127], v[36:39]
  ds_read2_b32 v[104:105], v235 offset0:80 offset1:81
  v_mfma_f32_16x16x32_bf16 v[40:43], v[144:147], v[132:135], v[40:43]
  ds_read2_b32 v[106:107], v235 offset0:82 offset1:83
  v_mfma_f32_16x16x32_bf16 v[44:47], v[144:147], v[140:143], v[44:47]
  ds_read_b128 v[108:111], v236 offset:11712
  v_mfma_f32_16x16x32_bf16 v[36:39], v[112:115], v[156:159], v[36:39]
  v_mfma_f32_16x16x32_bf16 v[40:43], v[120:123], v[156:159], v[40:43]
  v_mfma_f32_16x16x32_bf16 v[44:47], v[128:131], v[156:159], v[44:47]
  v_mfma_f32_16x16x32_bf16 v[36:39], v[152:155], v[116:119], v[36:39]
  v_mfma_f32_16x16x32_bf16 v[40:43], v[152:155], v[124:127], v[40:43]
  v_mfma_f32_16x16x32_bf16 v[44:47], v[152:155], v[132:135], v[44:47]
  v_mfma_f32_16x16x32_bf16 v[40:43], v[112:115], v[164:167], v[40:43]
  v_mfma_f32_16x16x32_bf16 v[44:47], v[120:123], v[164:167], v[44:47]
  v_mfma_f32_16x16x32_bf16 v[40:43], v[160:163], v[116:119], v[40:43]
  v_mfma_f32_16x16x32_bf16 v[44:47], v[160:163], v[124:127], v[44:47]
  v_mfma_f32_16x16x32_bf16 v[44:47], v[112:115], v[172:175], v[44:47]
  v_mfma_f32_16x16x32_bf16 v[44:47], v[168:171], v[116:119], v[44:47]
  s_waitcnt lgkmcnt(0)
  v_mfma_f32_16x16x32_bf16 v[16:19], v[48:51], v[52:55], v[16:19]
  ds_read2_b32 v[112:113], v232 offset0:192 offset1:193
  v_mfma_f32_16x16x32_bf16 v[20:23], v[48:51], v[60:63], v[20:23]
  ds_read2_b32 v[114:115], v232 offset0:194 offset1:195
  v_mfma_f32_16x16x32_bf16 v[20:23], v[56:59], v[52:55], v[20:23]
  ds_read_b128 v[116:119], v236 offset:768
  v_mfma_f32_16x16x32_bf16 v[24:27], v[56:59], v[60:63], v[24:27]
  ds_read2_b32 v[120:121], v232 offset0:64 offset1:65
  v_mfma_f32_16x16x32_bf16 v[24:27], v[48:51], v[68:71], v[24:27]
  ds_read2_b32 v[122:123], v232 offset0:66 offset1:67
  v_mfma_f32_16x16x32_bf16 v[28:31], v[56:59], v[68:71], v[28:31]
  ds_read_b128 v[124:127], v236 offset:2304
  v_mfma_f32_16x16x32_bf16 v[24:27], v[64:67], v[52:55], v[24:27]
  ds_read2_b32 v[128:129], v233 offset0:192 offset1:193
  v_mfma_f32_16x16x32_bf16 v[28:31], v[64:67], v[60:63], v[28:31]
  ds_read2_b32 v[130:131], v233 offset0:194 offset1:195
  v_mfma_f32_16x16x32_bf16 v[32:35], v[64:67], v[68:71], v[32:35]
  ds_read_b128 v[132:135], v236 offset:3840
  v_mfma_f32_16x16x32_bf16 v[28:31], v[48:51], v[76:79], v[28:31]
  ds_read2_b32 v[136:137], v233 offset0:64 offset1:65
  v_mfma_f32_16x16x32_bf16 v[32:35], v[56:59], v[76:79], v[32:35]
  ds_read2_b32 v[138:139], v233 offset0:66 offset1:67
  v_mfma_f32_16x16x32_bf16 v[36:39], v[64:67], v[76:79], v[36:39]
  ds_read_b128 v[140:143], v236 offset:5376
  v_mfma_f32_16x16x32_bf16 v[28:31], v[72:75], v[52:55], v[28:31]
  ds_read2_b32 v[144:145], v234 offset0:192 offset1:193
  v_mfma_f32_16x16x32_bf16 v[32:35], v[72:75], v[60:63], v[32:35]
  ds_read2_b32 v[146:147], v234 offset0:194 offset1:195
  v_mfma_f32_16x16x32_bf16 v[36:39], v[72:75], v[68:71], v[36:39]
  ds_read_b128 v[148:151], v236 offset:6912
  v_mfma_f32_16x16x32_bf16 v[40:43], v[72:75], v[76:79], v[40:43]
  ds_read2_b32 v[152:153], v234 offset0:64 offset1:65
  v_mfma_f32_16x16x32_bf16 v[32:35], v[48:51], v[84:87], v[32:35]
  ds_read2_b32 v[154:155], v234 offset0:66 offset1:67
  v_mfma_f32_16x16x32_bf16 v[36:39], v[56:59], v[84:87], v[36:39]
  ds_read_b128 v[156:159], v236 offset:8448
  v_mfma_f32_16x16x32_bf16 v[40:43], v[64:67], v[84:87], v[40:43]
  ds_read2_b32 v[160:161], v235 offset0:192 offset1:193
  v_mfma_f32_16x16x32_bf16 v[44:47], v[72:75], v[84:87], v[44:47]
  ds_read2_b32 v[162:163], v235 offset0:194 offset1:195
  v_mfma_f32_16x16x32_bf16 v[32:35], v[80:83], v[52:55], v[32:35]
  ds_read_b128 v[164:167], v236 offset:9984
  v_mfma_f32_16x16x32_bf16 v[36:39], v[80:83], v[60:63], v[36:39]
  ds_read2_b32 v[168:169], v235 offset0:64 offset1:65
  v_mfma_f32_16x16x32_bf16 v[40:43], v[80:83], v[68:71], v[40:43]
  ds_read2_b32 v[170:171], v235 offset0:66 offset1:67
  v_mfma_f32_16x16x32_bf16 v[44:47], v[80:83], v[76:79], v[44:47]
  ds_read_b128 v[172:175], v236 offset:11520
  v_mfma_f32_16x16x32_bf16 v[36:39], v[48:51], v[92:95], v[36:39]
  v_mfma_f32_16x16x32_bf16 v[40:43], v[56:59], v[92:95], v[40:43]
  v_mfma_f32_16x16x32_bf16 v[44:47], v[64:67], v[92:95], v[44:47]
  v_mfma_f32_16x16x32_bf16 v[36:39], v[88:91], v[52:55], v[36:39]
  v_mfma_f32_16x16x32_bf16 v[40:43], v[88:91], v[60:63], v[40:43]
  v_mfma_f32_16x16x32_bf16 v[44:47], v[88:91], v[68:71], v[44:47]
  v_mfma_f32_16x16x32_bf16 v[40:43], v[48:51], v[100:103], v[40:43]
  v_mfma_f32_16x16x32_bf16 v[44:47], v[56:59], v[100:103], v[44:47]
  v_mfma_f32_16x16x32_bf16 v[40:43], v[96:99], v[52:55], v[40:43]
  v_mfma_f32_16x16x32_bf16 v[44:47], v[96:99], v[60:63], v[44:47]
  v_mfma_f32_16x16x32_bf16 v[44:47], v[48:51], v[108:111], v[44:47]
  v_mfma_f32_16x16x32_bf16 v[44:47], v[104:107], v[52:55], v[44:47]
  s_waitcnt lgkmcnt(0)
  v_mfma_f32_16x16x32_bf16 v[16:19], v[112:115], v[116:119], v[16:19]
  ds_read2_b32 v[48:49], v232 offset0:176 offset1:177
  v_mfma_f32_16x16x32_bf16 v[20:23], v[112:115], v[124:127], v[20:23]
  ds_read2_b32 v[50:51], v232 offset0:178 offset1:179
  v_mfma_f32_16x16x32_bf16 v[20:23], v[120:123], v[116:119], v[20:23]
  ds_read_b128 v[52:55], v236 offset:576
  v_mfma_f32_16x16x32_bf16 v[24:27], v[120:123], v[124:127], v[24:27]
  ds_read2_b32 v[56:57], v232 offset0:48 offset1:49
  v_mfma_f32_16x16x32_bf16 v[24:27], v[112:115], v[132:135], v[24:27]
  ds_read2_b32 v[58:59], v232 offset0:50 offset1:51
  v_mfma_f32_16x16x32_bf16 v[28:31], v[120:123], v[132:135], v[28:31]
  ds_read_b128 v[60:63], v236 offset:2112
  v_mfma_f32_16x16x32_bf16 v[24:27], v[128:131], v[116:119], v[24:27]
  ds_read2_b32 v[64:65], v233 offset0:176 offset1:177
  v_mfma_f32_16x16x32_bf16 v[28:31], v[128:131], v[124:127], v[28:31]
  ds_read2_b32 v[66:67], v233 offset0:178 offset1:179
  v_mfma_f32_16x16x32_bf16 v[32:35], v[128:131], v[132:135], v[32:35]
  ds_read_b128 v[68:71], v236 offset:3648
  v_mfma_f32_16x16x32_bf16 v[28:31], v[112:115], v[140:143], v[28:31]
  ds_read2_b32 v[72:73], v233 offset0:48 offset1:49
  v_mfma_f32_16x16x32_bf16 v[32:35], v[120:123], v[140:143], v[32:35]
  ds_read2_b32 v[74:75], v233 offset0:50 offset1:51
  v_mfma_f32_16x16x32_bf16 v[36:39], v[128:131], v[140:143], v[36:39]
  ds_read_b128 v[76:79], v236 offset:5184
  v_mfma_f32_16x16x32_bf16 v[28:31], v[136:139], v[116:119], v[28:31]
  ds_read2_b32 v[80:81], v234 offset0:176 offset1:177
  v_mfma_f32_16x16x32_bf16 v[32:35], v[136:139], v[124:127], v[32:35]
  ds_read2_b32 v[82:83], v234 offset0:178 offset1:179
  v_mfma_f32_16x16x32_bf16 v[36:39], v[136:139], v[132:135], v[36:39]
  ds_read_b128 v[84:87], v236 offset:6720
  v_mfma_f32_16x16x32_bf16 v[40:43], v[136:139], v[140:143], v[40:43]
  ds_read2_b32 v[88:89], v234 offset0:48 offset1:49
  v_mfma_f32_16x16x32_bf16 v[32:35], v[112:115], v[148:151], v[32:35]
  ds_read2_b32 v[90:91], v234 offset0:50 offset1:51
  v_mfma_f32_16x16x32_bf16 v[36:39], v[120:123], v[148:151], v[36:39]
  ds_read_b128 v[92:95], v236 offset:8256
  v_mfma_f32_16x16x32_bf16 v[40:43], v[128:131], v[148:151], v[40:43]
  ds_read2_b32 v[96:97], v235 offset0:176 offset1:177
  v_mfma_f32_16x16x32_bf16 v[44:47], v[136:139], v[148:151], v[44:47]
  ds_read2_b32 v[98:99], v235 offset0:178 offset1:179
  v_mfma_f32_16x16x32_bf16 v[32:35], v[144:147], v[116:119], v[32:35]
  ds_read_b128 v[100:103], v236 offset:9792
  v_mfma_f32_16x16x32_bf16 v[36:39], v[144:147], v[124:127], v[36:39]
  ds_read2_b32 v[104:105], v235 offset0:48 offset1:49
  v_mfma_f32_16x16x32_bf16 v[40:43], v[144:147], v[132:135], v[40:43]
  ds_read2_b32 v[106:107], v235 offset0:50 offset1:51
  v_mfma_f32_16x16x32_bf16 v[44:47], v[144:147], v[140:143], v[44:47]
  ds_read_b128 v[108:111], v236 offset:11328
  v_mfma_f32_16x16x32_bf16 v[36:39], v[112:115], v[156:159], v[36:39]
  v_mfma_f32_16x16x32_bf16 v[40:43], v[120:123], v[156:159], v[40:43]
  v_mfma_f32_16x16x32_bf16 v[44:47], v[128:131], v[156:159], v[44:47]
  v_mfma_f32_16x16x32_bf16 v[36:39], v[152:155], v[116:119], v[36:39]
  v_mfma_f32_16x16x32_bf16 v[40:43], v[152:155], v[124:127], v[40:43]
  v_mfma_f32_16x16x32_bf16 v[44:47], v[152:155], v[132:135], v[44:47]
  v_mfma_f32_16x16x32_bf16 v[40:43], v[112:115], v[164:167], v[40:43]
  v_mfma_f32_16x16x32_bf16 v[44:47], v[120:123], v[164:167], v[44:47]
  v_mfma_f32_16x16x32_bf16 v[40:43], v[160:163], v[116:119], v[40:43]
  v_mfma_f32_16x16x32_bf16 v[44:47], v[160:163], v[124:127], v[44:47]
  v_mfma_f32_16x16x32_bf16 v[44:47], v[112:115], v[172:175], v[44:47]
  v_mfma_f32_16x16x32_bf16 v[44:47], v[168:171], v[116:119], v[44:47]
  s_waitcnt lgkmcnt(0)
  v_mfma_f32_16x16x32_bf16 v[16:19], v[48:51], v[52:55], v[16:19]
  ds_read2_b32 v[112:113], v232 offset0:160 offset1:161
  v_mfma_f32_16x16x32_bf16 v[20:23], v[48:51], v[60:63], v[20:23]
  ds_read2_b32 v[114:115], v232 offset0:162 offset1:163
  v_mfma_f32_16x16x32_bf16 v[20:23], v[56:59], v[52:55], v[20:23]
  ds_read_b128 v[116:119], v236 offset:384
  v_mfma_f32_16x16x32_bf16 v[24:27], v[56:59], v[60:63], v[24:27]
  ds_read2_b32 v[120:121], v232 offset0:32 offset1:33
  v_mfma_f32_16x16x32_bf16 v[24:27], v[48:51], v[68:71], v[24:27]
  ds_read2_b32 v[122:123], v232 offset0:34 offset1:35
  v_mfma_f32_16x16x32_bf16 v[28:31], v[56:59], v[68:71], v[28:31]
  ds_read_b128 v[124:127], v236 offset:1920
  v_mfma_f32_16x16x32_bf16 v[24:27], v[64:67], v[52:55], v[24:27]
  ds_read2_b32 v[128:129], v233 offset0:160 offset1:161
  v_mfma_f32_16x16x32_bf16 v[28:31], v[64:67], v[60:63], v[28:31]
  ds_read2_b32 v[130:131], v233 offset0:162 offset1:163
  v_mfma_f32_16x16x32_bf16 v[32:35], v[64:67], v[68:71], v[32:35]
  ds_read_b128 v[132:135], v236 offset:3456
  v_mfma_f32_16x16x32_bf16 v[28:31], v[48:51], v[76:79], v[28:31]
  ds_read2_b32 v[136:137], v233 offset0:32 offset1:33
  v_mfma_f32_16x16x32_bf16 v[32:35], v[56:59], v[76:79], v[32:35]
  ds_read2_b32 v[138:139], v233 offset0:34 offset1:35
  v_mfma_f32_16x16x32_bf16 v[36:39], v[64:67], v[76:79], v[36:39]
  ds_read_b128 v[140:143], v236 offset:4992
  v_mfma_f32_16x16x32_bf16 v[28:31], v[72:75], v[52:55], v[28:31]
  ds_read2_b32 v[144:145], v234 offset0:160 offset1:161
  v_mfma_f32_16x16x32_bf16 v[32:35], v[72:75], v[60:63], v[32:35]
  ds_read2_b32 v[146:147], v234 offset0:162 offset1:163
  v_mfma_f32_16x16x32_bf16 v[36:39], v[72:75], v[68:71], v[36:39]
  ds_read_b128 v[148:151], v236 offset:6528
  v_mfma_f32_16x16x32_bf16 v[40:43], v[72:75], v[76:79], v[40:43]
  ds_read2_b32 v[152:153], v234 offset0:32 offset1:33
  v_mfma_f32_16x16x32_bf16 v[32:35], v[48:51], v[84:87], v[32:35]
  ds_read2_b32 v[154:155], v234 offset0:34 offset1:35
  v_mfma_f32_16x16x32_bf16 v[36:39], v[56:59], v[84:87], v[36:39]
  ds_read_b128 v[156:159], v236 offset:8064
  v_mfma_f32_16x16x32_bf16 v[40:43], v[64:67], v[84:87], v[40:43]
  ds_read2_b32 v[160:161], v235 offset0:160 offset1:161
  v_mfma_f32_16x16x32_bf16 v[44:47], v[72:75], v[84:87], v[44:47]
  ds_read2_b32 v[162:163], v235 offset0:162 offset1:163
  v_mfma_f32_16x16x32_bf16 v[32:35], v[80:83], v[52:55], v[32:35]
  ds_read_b128 v[164:167], v236 offset:9600
  v_mfma_f32_16x16x32_bf16 v[36:39], v[80:83], v[60:63], v[36:39]
  ds_read2_b32 v[168:169], v235 offset0:32 offset1:33
  v_mfma_f32_16x16x32_bf16 v[40:43], v[80:83], v[68:71], v[40:43]
  ds_read2_b32 v[170:171], v235 offset0:34 offset1:35
  v_mfma_f32_16x16x32_bf16 v[44:47], v[80:83], v[76:79], v[44:47]
  ds_read_b128 v[172:175], v236 offset:11136
  v_mfma_f32_16x16x32_bf16 v[36:39], v[48:51], v[92:95], v[36:39]
  v_mfma_f32_16x16x32_bf16 v[40:43], v[56:59], v[92:95], v[40:43]
  v_mfma_f32_16x16x32_bf16 v[44:47], v[64:67], v[92:95], v[44:47]
  v_mfma_f32_16x16x32_bf16 v[36:39], v[88:91], v[52:55], v[36:39]
  v_mfma_f32_16x16x32_bf16 v[40:43], v[88:91], v[60:63], v[40:43]
  v_mfma_f32_16x16x32_bf16 v[44:47], v[88:91], v[68:71], v[44:47]
  v_mfma_f32_16x16x32_bf16 v[40:43], v[48:51], v[100:103], v[40:43]
  v_mfma_f32_16x16x32_bf16 v[44:47], v[56:59], v[100:103], v[44:47]
  v_mfma_f32_16x16x32_bf16 v[40:43], v[96:99], v[52:55], v[40:43]
  v_mfma_f32_16x16x32_bf16 v[44:47], v[96:99], v[60:63], v[44:47]
  v_mfma_f32_16x16x32_bf16 v[44:47], v[48:51], v[108:111], v[44:47]
  v_mfma_f32_16x16x32_bf16 v[44:47], v[104:107], v[52:55], v[44:47]
  s_waitcnt lgkmcnt(0)
  v_mfma_f32_16x16x32_bf16 v[16:19], v[112:115], v[116:119], v[16:19]
  ds_read2_b32 v[48:49], v232 offset0:144 offset1:145
  v_mfma_f32_16x16x32_bf16 v[20:23], v[112:115], v[124:127], v[20:23]
  ds_read2_b32 v[50:51], v232 offset0:146 offset1:147
  v_mfma_f32_16x16x32_bf16 v[20:23], v[120:123], v[116:119], v[20:23]
  ds_read_b128 v[52:55], v236 offset:192
  v_mfma_f32_16x16x32_bf16 v[24:27], v[120:123], v[124:127], v[24:27]
  ds_read2_b32 v[56:57], v232 offset0:16 offset1:17
  v_mfma_f32_16x16x32_bf16 v[24:27], v[112:115], v[132:135], v[24:27]
  ds_read2_b32 v[58:59], v232 offset0:18 offset1:19
  v_mfma_f32_16x16x32_bf16 v[28:31], v[120:123], v[132:135], v[28:31]
  ds_read_b128 v[60:63], v236 offset:1728
  v_mfma_f32_16x16x32_bf16 v[24:27], v[128:131], v[116:119], v[24:27]
  ds_read2_b32 v[64:65], v233 offset0:144 offset1:145
  v_mfma_f32_16x16x32_bf16 v[28:31], v[128:131], v[124:127], v[28:31]
  ds_read2_b32 v[66:67], v233 offset0:146 offset1:147
  v_mfma_f32_16x16x32_bf16 v[32:35], v[128:131], v[132:135], v[32:35]
  ds_read_b128 v[68:71], v236 offset:3264
  v_mfma_f32_16x16x32_bf16 v[28:31], v[112:115], v[140:143], v[28:31]
  ds_read2_b32 v[72:73], v233 offset0:16 offset1:17
  v_mfma_f32_16x16x32_bf16 v[32:35], v[120:123], v[140:143], v[32:35]
  ds_read2_b32 v[74:75], v233 offset0:18 offset1:19
  v_mfma_f32_16x16x32_bf16 v[36:39], v[128:131], v[140:143], v[36:39]
  ds_read_b128 v[76:79], v236 offset:4800
  v_mfma_f32_16x16x32_bf16 v[28:31], v[136:139], v[116:119], v[28:31]
  ds_read2_b32 v[80:81], v234 offset0:144 offset1:145
  v_mfma_f32_16x16x32_bf16 v[32:35], v[136:139], v[124:127], v[32:35]
  ds_read2_b32 v[82:83], v234 offset0:146 offset1:147
  v_mfma_f32_16x16x32_bf16 v[36:39], v[136:139], v[132:135], v[36:39]
  ds_read_b128 v[84:87], v236 offset:6336
  v_mfma_f32_16x16x32_bf16 v[40:43], v[136:139], v[140:143], v[40:43]
  ds_read2_b32 v[88:89], v234 offset0:16 offset1:17
  v_mfma_f32_16x16x32_bf16 v[32:35], v[112:115], v[148:151], v[32:35]
  ds_read2_b32 v[90:91], v234 offset0:18 offset1:19
  v_mfma_f32_16x16x32_bf16 v[36:39], v[120:123], v[148:151], v[36:39]
  ds_read_b128 v[92:95], v236 offset:7872
  v_mfma_f32_16x16x32_bf16 v[40:43], v[128:131], v[148:151], v[40:43]
  ds_read2_b32 v[96:97], v235 offset0:144 offset1:145
  v_mfma_f32_16x16x32_bf16 v[44:47], v[136:139], v[148:151], v[44:47]
  ds_read2_b32 v[98:99], v235 offset0:146 offset1:147
  v_mfma_f32_16x16x32_bf16 v[32:35], v[144:147], v[116:119], v[32:35]
  ds_read_b128 v[100:103], v236 offset:9408
  v_mfma_f32_16x16x32_bf16 v[36:39], v[144:147], v[124:127], v[36:39]
  ds_read2_b32 v[104:105], v235 offset0:16 offset1:17
  v_mfma_f32_16x16x32_bf16 v[40:43], v[144:147], v[132:135], v[40:43]
  ds_read2_b32 v[106:107], v235 offset0:18 offset1:19
  v_mfma_f32_16x16x32_bf16 v[44:47], v[144:147], v[140:143], v[44:47]
  ds_read_b128 v[108:111], v236 offset:10944
  v_mfma_f32_16x16x32_bf16 v[36:39], v[112:115], v[156:159], v[36:39]
  v_mfma_f32_16x16x32_bf16 v[40:43], v[120:123], v[156:159], v[40:43]
  v_mfma_f32_16x16x32_bf16 v[44:47], v[128:131], v[156:159], v[44:47]
  v_mfma_f32_16x16x32_bf16 v[36:39], v[152:155], v[116:119], v[36:39]
  v_mfma_f32_16x16x32_bf16 v[40:43], v[152:155], v[124:127], v[40:43]
  v_mfma_f32_16x16x32_bf16 v[44:47], v[152:155], v[132:135], v[44:47]
  v_mfma_f32_16x16x32_bf16 v[40:43], v[112:115], v[164:167], v[40:43]
  v_mfma_f32_16x16x32_bf16 v[44:47], v[120:123], v[164:167], v[44:47]
  v_mfma_f32_16x16x32_bf16 v[40:43], v[160:163], v[116:119], v[40:43]
  v_mfma_f32_16x16x32_bf16 v[44:47], v[160:163], v[124:127], v[44:47]
  v_mfma_f32_16x16x32_bf16 v[44:47], v[112:115], v[172:175], v[44:47]
  v_mfma_f32_16x16x32_bf16 v[44:47], v[168:171], v[116:119], v[44:47]
  s_waitcnt lgkmcnt(0)
  v_mfma_f32_16x16x32_bf16 v[16:19], v[48:51], v[52:55], v[16:19]
  ds_read2_b32 v[112:113], v232 offset0:128 offset1:129
  v_mfma_f32_16x16x32_bf16 v[20:23], v[48:51], v[60:63], v[20:23]
  ds_read2_b32 v[114:115], v232 offset0:130 offset1:131
  v_mfma_f32_16x16x32_bf16 v[20:23], v[56:59], v[52:55], v[20:23]
  ds_read_b128 v[116:119], v236 offset:0
  v_mfma_f32_16x16x32_bf16 v[24:27], v[56:59], v[60:63], v[24:27]
  ds_read2_b32 v[120:121], v232 offset0:0 offset1:1
  v_mfma_f32_16x16x32_bf16 v[24:27], v[48:51], v[68:71], v[24:27]
  ds_read2_b32 v[122:123], v232 offset0:2 offset1:3
  v_mfma_f32_16x16x32_bf16 v[28:31], v[56:59], v[68:71], v[28:31]
  ds_read_b128 v[124:127], v236 offset:1536
  v_mfma_f32_16x16x32_bf16 v[24:27], v[64:67], v[52:55], v[24:27]
  ds_read2_b32 v[128:129], v233 offset0:128 offset1:129
  v_mfma_f32_16x16x32_bf16 v[28:31], v[64:67], v[60:63], v[28:31]
  ds_read2_b32 v[130:131], v233 offset0:130 offset1:131
  v_mfma_f32_16x16x32_bf16 v[32:35], v[64:67], v[68:71], v[32:35]
  ds_read_b128 v[132:135], v236 offset:3072
  v_mfma_f32_16x16x32_bf16 v[28:31], v[48:51], v[76:79], v[28:31]
  ds_read2_b32 v[136:137], v233 offset0:0 offset1:1
  v_mfma_f32_16x16x32_bf16 v[32:35], v[56:59], v[76:79], v[32:35]
  ds_read2_b32 v[138:139], v233 offset0:2 offset1:3
  v_mfma_f32_16x16x32_bf16 v[36:39], v[64:67], v[76:79], v[36:39]
  ds_read_b128 v[140:143], v236 offset:4608
  v_mfma_f32_16x16x32_bf16 v[28:31], v[72:75], v[52:55], v[28:31]
  ds_read2_b32 v[144:145], v234 offset0:128 offset1:129
  v_mfma_f32_16x16x32_bf16 v[32:35], v[72:75], v[60:63], v[32:35]
  ds_read2_b32 v[146:147], v234 offset0:130 offset1:131
  v_mfma_f32_16x16x32_bf16 v[36:39], v[72:75], v[68:71], v[36:39]
  ds_read_b128 v[148:151], v236 offset:6144
  v_mfma_f32_16x16x32_bf16 v[40:43], v[72:75], v[76:79], v[40:43]
  ds_read2_b32 v[152:153], v234 offset0:0 offset1:1
  v_mfma_f32_16x16x32_bf16 v[32:35], v[48:51], v[84:87], v[32:35]
  ds_read2_b32 v[154:155], v234 offset0:2 offset1:3
  v_mfma_f32_16x16x32_bf16 v[36:39], v[56:59], v[84:87], v[36:39]
  ds_read_b128 v[156:159], v236 offset:7680
  v_mfma_f32_16x16x32_bf16 v[40:43], v[64:67], v[84:87], v[40:43]
  ds_read2_b32 v[160:161], v235 offset0:128 offset1:129
  v_mfma_f32_16x16x32_bf16 v[44:47], v[72:75], v[84:87], v[44:47]
  ds_read2_b32 v[162:163], v235 offset0:130 offset1:131
  v_mfma_f32_16x16x32_bf16 v[32:35], v[80:83], v[52:55], v[32:35]
  ds_read_b128 v[164:167], v236 offset:9216
  v_mfma_f32_16x16x32_bf16 v[36:39], v[80:83], v[60:63], v[36:39]
  ds_read2_b32 v[168:169], v235 offset0:0 offset1:1
  v_mfma_f32_16x16x32_bf16 v[40:43], v[80:83], v[68:71], v[40:43]
  ds_read2_b32 v[170:171], v235 offset0:2 offset1:3
  v_mfma_f32_16x16x32_bf16 v[44:47], v[80:83], v[76:79], v[44:47]
  ds_read_b128 v[172:175], v236 offset:10752
  v_mfma_f32_16x16x32_bf16 v[36:39], v[48:51], v[92:95], v[36:39]
  v_mfma_f32_16x16x32_bf16 v[40:43], v[56:59], v[92:95], v[40:43]
  v_mfma_f32_16x16x32_bf16 v[44:47], v[64:67], v[92:95], v[44:47]
  v_mfma_f32_16x16x32_bf16 v[36:39], v[88:91], v[52:55], v[36:39]
  v_mfma_f32_16x16x32_bf16 v[40:43], v[88:91], v[60:63], v[40:43]
  v_mfma_f32_16x16x32_bf16 v[44:47], v[88:91], v[68:71], v[44:47]
  v_mfma_f32_16x16x32_bf16 v[40:43], v[48:51], v[100:103], v[40:43]
  v_mfma_f32_16x16x32_bf16 v[44:47], v[56:59], v[100:103], v[44:47]
  v_mfma_f32_16x16x32_bf16 v[40:43], v[96:99], v[52:55], v[40:43]
  v_mfma_f32_16x16x32_bf16 v[44:47], v[96:99], v[60:63], v[44:47]
  v_mfma_f32_16x16x32_bf16 v[44:47], v[48:51], v[108:111], v[44:47]
  v_mfma_f32_16x16x32_bf16 v[44:47], v[104:107], v[52:55], v[44:47]
  s_waitcnt lgkmcnt(0)
  v_mfma_f32_16x16x32_bf16 v[16:19], v[112:115], v[116:119], v[16:19]
  ds_read_b64 v[48:49], v242 offset:1440
  v_mfma_f32_16x16x32_bf16 v[20:23], v[112:115], v[124:127], v[20:23]
  ds_read_b64 v[50:51], v242 offset:2976
  v_mfma_f32_16x16x32_bf16 v[20:23], v[120:123], v[116:119], v[20:23]
  ds_read_b64 v[52:53], v242 offset:4512
  v_mfma_f32_16x16x32_bf16 v[24:27], v[120:123], v[124:127], v[24:27]
  ds_read_b64 v[54:55], v242 offset:6048
  v_mfma_f32_16x16x32_bf16 v[24:27], v[112:115], v[132:135], v[24:27]
  ds_read_b64 v[56:57], v242 offset:7584
  v_mfma_f32_16x16x32_bf16 v[28:31], v[120:123], v[132:135], v[28:31]
  ds_read_b64 v[58:59], v242 offset:9120
  v_mfma_f32_16x16x32_bf16 v[24:27], v[128:131], v[116:119], v[24:27]
  ds_read_b64 v[60:61], v242 offset:10656
  v_mfma_f32_16x16x32_bf16 v[28:31], v[128:131], v[124:127], v[28:31]
  ds_read_b64 v[62:63], v242 offset:12192
  v_mfma_f32_16x16x32_bf16 v[32:35], v[128:131], v[132:135], v[32:35]
  v_mfma_f32_16x16x32_bf16 v[28:31], v[112:115], v[140:143], v[28:31]
  v_mfma_f32_16x16x32_bf16 v[32:35], v[120:123], v[140:143], v[32:35]
  v_mfma_f32_16x16x32_bf16 v[36:39], v[128:131], v[140:143], v[36:39]
  v_mfma_f32_16x16x32_bf16 v[28:31], v[136:139], v[116:119], v[28:31]
  v_mfma_f32_16x16x32_bf16 v[32:35], v[136:139], v[124:127], v[32:35]
  v_mfma_f32_16x16x32_bf16 v[36:39], v[136:139], v[132:135], v[36:39]
  v_mfma_f32_16x16x32_bf16 v[40:43], v[136:139], v[140:143], v[40:43]
  v_mfma_f32_16x16x32_bf16 v[32:35], v[112:115], v[148:151], v[32:35]
  v_mfma_f32_16x16x32_bf16 v[36:39], v[120:123], v[148:151], v[36:39]
  v_mfma_f32_16x16x32_bf16 v[40:43], v[128:131], v[148:151], v[40:43]
  v_mfma_f32_16x16x32_bf16 v[44:47], v[136:139], v[148:151], v[44:47]
  v_mfma_f32_16x16x32_bf16 v[32:35], v[144:147], v[116:119], v[32:35]
  v_mfma_f32_16x16x32_bf16 v[36:39], v[144:147], v[124:127], v[36:39]
  v_mfma_f32_16x16x32_bf16 v[40:43], v[144:147], v[132:135], v[40:43]
  v_mfma_f32_16x16x32_bf16 v[44:47], v[144:147], v[140:143], v[44:47]
  v_mfma_f32_16x16x32_bf16 v[36:39], v[112:115], v[156:159], v[36:39]
  v_mfma_f32_16x16x32_bf16 v[40:43], v[120:123], v[156:159], v[40:43]
  v_mfma_f32_16x16x32_bf16 v[44:47], v[128:131], v[156:159], v[44:47]
  v_mfma_f32_16x16x32_bf16 v[36:39], v[152:155], v[116:119], v[36:39]
  v_mfma_f32_16x16x32_bf16 v[40:43], v[152:155], v[124:127], v[40:43]
  v_mfma_f32_16x16x32_bf16 v[44:47], v[152:155], v[132:135], v[44:47]
  v_mfma_f32_16x16x32_bf16 v[40:43], v[112:115], v[164:167], v[40:43]
  v_mfma_f32_16x16x32_bf16 v[44:47], v[120:123], v[164:167], v[44:47]
  v_mfma_f32_16x16x32_bf16 v[40:43], v[160:163], v[116:119], v[40:43]
  v_mfma_f32_16x16x32_bf16 v[44:47], v[160:163], v[124:127], v[44:47]
  v_mfma_f32_16x16x32_bf16 v[44:47], v[112:115], v[172:175], v[44:47]
  v_mfma_f32_16x16x32_bf16 v[44:47], v[168:171], v[116:119], v[44:47]
  v_mov_b32 v15, 0xffff0000
  s_waitcnt lgkmcnt(0)
  v_lshlrev_b32 v66, 16, v48
  v_and_b32 v67, v15, v48
  v_lshlrev_b32 v68, 16, v49
  v_and_b32 v69, v15, v49
  v_fmac_f32 v16, s58, v66
  v_fmac_f32 v17, s58, v67
  v_fmac_f32 v18, s58, v68
  v_fmac_f32 v19, s58, v69
  v_cvt_pk_bf16_f32 v70, v16, v17
  v_cvt_pk_bf16_f32 v71, v18, v19
  ds_write_b64 v237, v[70:71] offset:0
  v_lshlrev_b32 v74, 16, v50
  v_and_b32 v75, v15, v50
  v_lshlrev_b32 v76, 16, v51
  v_and_b32 v77, v15, v51
  v_fmac_f32 v20, s58, v74
  v_fmac_f32 v21, s58, v75
  v_fmac_f32 v22, s58, v76
  v_fmac_f32 v23, s58, v77
  v_cvt_pk_bf16_f32 v78, v20, v21
  v_cvt_pk_bf16_f32 v79, v22, v23
  ds_write_b64 v237, v[78:79] offset:512
  ds_read_b128 v[80:83], v238 offset:0
  v_lshlrev_b32 v66, 16, v52
  v_and_b32 v67, v15, v52
  v_lshlrev_b32 v68, 16, v53
  v_and_b32 v69, v15, v53
  v_fmac_f32 v24, s58, v66
  v_fmac_f32 v25, s58, v67
  v_fmac_f32 v26, s58, v68
  v_fmac_f32 v27, s58, v69
  v_cvt_pk_bf16_f32 v70, v24, v25
  v_cvt_pk_bf16_f32 v71, v26, v27
  ds_write_b64 v237, v[70:71] offset:1024
  v_lshlrev_b32 v74, 16, v54
  v_and_b32 v75, v15, v54
  v_lshlrev_b32 v76, 16, v55
  v_and_b32 v77, v15, v55
  v_fmac_f32 v28, s58, v74
  v_fmac_f32 v29, s58, v75
  v_fmac_f32 v30, s58, v76
  v_fmac_f32 v31, s58, v77
  v_cvt_pk_bf16_f32 v78, v28, v29
  v_cvt_pk_bf16_f32 v79, v30, v31
  ds_write_b64 v237, v[78:79] offset:1536
  ds_read_b128 v[84:87], v238 offset:1024
  v_lshlrev_b32 v66, 16, v56
  v_and_b32 v67, v15, v56
  v_lshlrev_b32 v68, 16, v57
  v_and_b32 v69, v15, v57
  v_fmac_f32 v32, s58, v66
  v_fmac_f32 v33, s58, v67
  v_fmac_f32 v34, s58, v68
  v_fmac_f32 v35, s58, v69
  v_cvt_pk_bf16_f32 v70, v32, v33
  v_cvt_pk_bf16_f32 v71, v34, v35
  ds_write_b64 v237, v[70:71] offset:2048
  v_lshlrev_b32 v74, 16, v58
  v_and_b32 v75, v15, v58
  v_lshlrev_b32 v76, 16, v59
  v_and_b32 v77, v15, v59
  v_fmac_f32 v36, s58, v74
  v_fmac_f32 v37, s58, v75
  v_fmac_f32 v38, s58, v76
  v_fmac_f32 v39, s58, v77
  v_cvt_pk_bf16_f32 v78, v36, v37
  v_cvt_pk_bf16_f32 v79, v38, v39
  ds_write_b64 v237, v[78:79] offset:2560
  ds_read_b128 v[88:91], v238 offset:2048
  v_lshlrev_b32 v66, 16, v60
  v_and_b32 v67, v15, v60
  v_lshlrev_b32 v68, 16, v61
  v_and_b32 v69, v15, v61
  v_fmac_f32 v40, s58, v66
  v_fmac_f32 v41, s58, v67
  v_fmac_f32 v42, s58, v68
  v_fmac_f32 v43, s58, v69
  v_cvt_pk_bf16_f32 v70, v40, v41
  v_cvt_pk_bf16_f32 v71, v42, v43
  ds_write_b64 v237, v[70:71] offset:3072
  v_lshlrev_b32 v74, 16, v62
  v_and_b32 v75, v15, v62
  v_lshlrev_b32 v76, 16, v63
  v_and_b32 v77, v15, v63
  v_fmac_f32 v44, s58, v74
  v_fmac_f32 v45, s58, v75
  v_fmac_f32 v46, s58, v76
  v_fmac_f32 v47, s58, v77
  v_cvt_pk_bf16_f32 v78, v44, v45
  v_cvt_pk_bf16_f32 v79, v46, v47
  ds_write_b64 v237, v[78:79] offset:3584
  ds_read_b128 v[92:95], v238 offset:3072
  s_lshl_b32 s22, s47, 12
  s_add_u32 s22, s22, 20971520
  s_waitcnt lgkmcnt(9)
  buffer_store_dwordx4 v[80:83], v239, s[36:39], s22 offen offset:0 sc1
  s_waitcnt lgkmcnt(6)
  buffer_store_dwordx4 v[84:87], v239, s[36:39], s22 offen offset:1024 sc1
  s_waitcnt lgkmcnt(3)
  buffer_store_dwordx4 v[88:91], v239, s[36:39], s22 offen offset:2048 sc1
  s_waitcnt lgkmcnt(0)
  buffer_store_dwordx4 v[92:95], v239, s[36:39], s22 offen offset:3072 sc1
  s_lshl_b32 s22, s3, 10
  s_lshl_b32 s23, s59, 2
  s_add_u32 s22, s22, s23
  s_add_u32 s22, s22, 27279744
  s_add_u32 s23, s22, 8192
  v_mov_b32 v4, s100
  v_mov_b32 v5, 0
  s_mov_b64 exec, 1
  s_waitcnt vmcnt(0)
  buffer_store_dword v4, v5, s[36:39], s22 offen
  buffer_store_dword v4, v5, s[36:39], s23 offen sc1
  s_mov_b64 exec, -1
  v_min_u32 v6, 19, v1
  v_lshlrev_b32 v6, 4, v6
  s_lshl_b32 s20, s3, 10
  s_add_u32 s20, s20, 27279744
  buffer_load_dwordx4 v[8:11], v6, s[36:39], s20 offen sc1
  s_lshl_b32 s22, s3, 7
  s_add_u32 s22, s22, 27271168
  s_waitcnt vmcnt(0)
  v_cmp_ne_u32 vcc, s100, v8
  v_cmp_ne_u32 s[62:63], s100, v9
  s_nop 2
  s_or_b64 vcc, vcc, s[62:63]
  v_cmp_ne_u32 s[62:63], s100, v10
  s_nop 2
  s_or_b64 vcc, vcc, s[62:63]
  v_cmp_ne_u32 s[62:63], s100, v11
  s_nop 2
  s_or_b64 vcc, vcc, s[62:63]
  s_cbranch_vccnz K_NY
  v_mov_b32 v4, s100
  v_mov_b32 v5, 0
  s_mov_b64 exec, 1
  buffer_store_dword v4, v5, s[36:39], s22 offen sc1
  s_mov_b64 exec, -1
K_NY:
  s_endpgm
M_G:
  s_setprio 2
  s_lshr_b32 s18, s13, 1
  s_and_b32 s19, s13, 1
  v_and_b32 v10, 15, v1
  v_lshrrev_b32 v11, 4, v1
  v_lshlrev_b32 v12, 1, v10
  s_lshl_b32 s22, s16, 8
  s_lshl_b32 s23, s19, 7
  s_add_u32 s22, s22, s23
  s_mov_b32 s32, s50
  s_and_b32 s33, s51, 0xffff
  s_mov_b32 s34, 3456
  s_mov_b32 s35, 0x20000
  buffer_load_ushort v172, v12, s[32:35], s22 offen offset:0
  buffer_load_ushort v173, v12, s[32:35], s22 offen offset:32
  buffer_load_ushort v174, v12, s[32:35], s22 offen offset:64
  buffer_load_ushort v175, v12, s[32:35], s22 offen offset:96
  s_add_u32 s8, s6, 27262976
  s_addc_u32 s9, s7, 0
  s_load_dword s100, s[8:9], 0
  s_mov_b32 s36, s6
  s_and_b32 s37, s7, 0xffff
  s_mov_b32 s38, 33554432
  s_mov_b32 s39, 0x20000
  v_lshrrev_b32 v12, 2, v1
  v_and_b32 v13, 7, v12
  s_lshl_b32 s22, s19, 2
  v_xor_b32 v13, s22, v13
  v_lshlrev_b32 v13, 5, v13
  v_lshl_add_u32 v13, v12, 8, v13
  v_and_b32 v12, 3, v1
  v_lshl_add_u32 v13, v12, 3, v13
  v_add_u32 v2, 16384, v13
  v_xor_b32 v3, 32, v2
  v_xor_b32 v4, 64, v2
  v_xor_b32 v5, 96, v2
  v_lshrrev_b32 v12, 1, v10
  v_xor_b32 v12, v12, v11
  v_lshlrev_b32 v12, 4, v12
  v_and_b32 v13, 7, v10
  v_lshl_add_u32 v12, v13, 7, v12
  v_lshrrev_b32 v13, 3, v10
  v_lshl_add_u32 v12, v13, 12, v12
  s_lshl_b32 s22, s18, 13
  v_add_u32 v8, s22, v12
  v_xor_b32 v9, 64, v8
  v_lshlrev_b32 v14, 4, v1
  v_lshlrev_b32 v15, 3, v10
  s_lshl_b32 s60, s15, 10
  s_lshl_b32 s22, s18, 9
  s_add_u32 s60, s60, s22
  s_add_u32 s60, s60, 25165824
  v_and_b32 v13, 31, v1
  v_lshlrev_b32 v13, 2, v13
  s_lshl_b32 s61, s3, 7
  s_add_u32 s61, s61, 27266048
  v_and_b32 v12, 7, v1
  v_lshlrev_b32 v12, 7, v12
  s_mov_b32 s63, 27265024
  v_mov_b32 v160, 0x3f803f80
  v_mov_b32 v161, 0x3f803f80
  v_mov_b32 v162, 0x3f803f80
  v_mov_b32 v163, 0x3f803f80
  s_waitcnt lgkmcnt(0)
  s_mul_i32 s100, s100, 1664525
  s_add_u32 s100, s100, 1013904223
  s_or_b32 s100, s100, 0x100
  v_mov_b32 v220, 0x3f803f80
  v_mov_b32 v221, 0xffff0000
  v_mov_b32 v212, 0
  v_mov_b32 v213, 0
  v_mov_b32 v214, 0
  v_mov_b32 v215, 0
  s_mul_i32 s22, s13, 2688
  s_add_u32 s22, s22, 142848
  v_mul_u32_u24 v226, 1344, v6
  v_lshl_add_u32 v226, v7, 3, v226
  v_add_u32 v226, s22, v226
  v_lshlrev_b32 v227, 3, v6
  s_lshl_b32 s22, s101, 6
  s_lshl_b32 s23, s13, 4
  s_add_u32 s22, s22, s23
  s_add_u32 s22, s22, 25165824
  s_add_u32 s23, s22, 65536
  s_waitcnt vmcnt(4)
  v_dot2_f32_bf16 v212, v200, v220, v212
  v_dot2_f32_bf16 v214, v200, v200, v214
  v_dot2_f32_bf16 v213, v201, v220, v213
  v_dot2_f32_bf16 v215, v201, v201, v215
  v_dot2_f32_bf16 v212, v202, v220, v212
  v_dot2_f32_bf16 v214, v202, v202, v214
  v_dot2_f32_bf16 v213, v203, v220, v213
  v_dot2_f32_bf16 v215, v203, v203, v215
  v_dot2_f32_bf16 v212, v204, v220, v212
  v_dot2_f32_bf16 v214, v204, v204, v214
  v_dot2_f32_bf16 v213, v205, v220, v213
  v_dot2_f32_bf16 v215, v205, v205, v215
  v_dot2_f32_bf16 v212, v206, v220, v212
  v_dot2_f32_bf16 v214, v206, v206, v214
  v_dot2_f32_bf16 v213, v207, v220, v213
  v_dot2_f32_bf16 v215, v207, v207, v215
  v_dot2_f32_bf16 v212, v208, v220, v212
  v_dot2_f32_bf16 v214, v208, v208, v214
  v_dot2_f32_bf16 v213, v209, v220, v213
  v_dot2_f32_bf16 v215, v209, v209, v215
  s_nop 1
  v_add_f32 v212, v212, v213
  v_add_f32 v214, v214, v215
  s_nop 0
  v_add_f32_dpp v212, v212, v212 quad_perm:[1,0,3,2] row_mask:0xf bank_mask:0xf
  v_add_f32_dpp v214, v214, v214 quad_perm:[1,0,3,2] row_mask:0xf bank_mask:0xf
  s_nop 0
  v_add_f32_dpp v212, v212, v212 quad_perm:[2,3,0,1] row_mask:0xf bank_mask:0xf
  v_add_f32_dpp v214, v214, v214 quad_perm:[2,3,0,1] row_mask:0xf bank_mask:0xf
  s_nop 0
  v_add_f32_dpp v212, v212, v212 row_half_mirror row_mask:0xf bank_mask:0xf
  v_add_f32_dpp v214, v214, v214 row_half_mirror row_mask:0xf bank_mask:0xf
  s_nop 0
  v_add_f32_dpp v212, v212, v212 row_mirror row_mask:0xf bank_mask:0xf
  v_add_f32_dpp v214, v214, v214 row_mirror row_mask:0xf bank_mask:0xf
  v_mov_b32 v213, v212
  v_mov_b32 v215, v214
  s_nop 0
  v_permlane16_swap_b32 v212, v213
  v_permlane16_swap_b32 v214, v215
  v_add_f32 v212, v212, v213
  v_add_f32 v214, v214, v215
  v_mul_f32 v212, 0x3acccccd, v212
  v_mul_f32 v214, 0x3acccccd, v214
  v_fma_f32 v214, -v212, v212, v214
  v_max_f32 v214, 0, v214
  v_cvt_pk_bf16_f32 v214, v214, v214
  v_lshlrev_b32 v214, 16, v214
  v_add_f32 v214, 0x3727c5ac, v214
  v_cvt_pk_bf16_f32 v214, v214, v214
  v_lshlrev_b32 v214, 16, v214
  v_sqrt_f32 v214, v214
  v_mov_b32 v217, s100
  v_cvt_pk_bf16_f32 v216, v212, v214
  s_mov_b32 exec_lo, 1
  s_mov_b32 exec_hi, 1
  buffer_store_dwordx2 v[216:217], v227, s[36:39], s22 offen sc1
  s_mov_b64 exec, -1
  v_and_b32 v214, v221, v216
  v_lshlrev_b32 v212, 16, v216
  v_rcp_f32 v214, v214
  v_lshlrev_b32 v222, 16, v200
  v_lshlrev_b32 v224, 16, v201
  v_and_b32 v223, v221, v200
  v_and_b32 v225, v221, v201
  v_sub_f32 v222, v222, v212
  v_sub_f32 v224, v224, v212
  v_sub_f32 v223, v223, v212
  v_sub_f32 v225, v225, v212
  v_cvt_pk_bf16_f32 v200, v222, v223
  v_cvt_pk_bf16_f32 v201, v224, v225
  v_lshlrev_b32 v222, 16, v200
  v_lshlrev_b32 v224, 16, v201
  v_and_b32 v223, v221, v200
  v_and_b32 v225, v221, v201
  v_mul_f32 v222, v222, v214
  v_mul_f32 v224, v224, v214
  v_mul_f32 v223, v223, v214
  v_mul_f32 v225, v225, v214
  v_cvt_pk_bf16_f32 v200, v222, v223
  v_cvt_pk_bf16_f32 v201, v224, v225
  ds_write_b64 v226, v[200:201] offset:0
  v_lshlrev_b32 v222, 16, v202
  v_lshlrev_b32 v224, 16, v203
  v_and_b32 v223, v221, v202
  v_and_b32 v225, v221, v203
  v_sub_f32 v222, v222, v212
  v_sub_f32 v224, v224, v212
  v_sub_f32 v223, v223, v212
  v_sub_f32 v225, v225, v212
  v_cvt_pk_bf16_f32 v202, v222, v223
  v_cvt_pk_bf16_f32 v203, v224, v225
  v_lshlrev_b32 v222, 16, v202
  v_lshlrev_b32 v224, 16, v203
  v_and_b32 v223, v221, v202
  v_and_b32 v225, v221, v203
  v_mul_f32 v222, v222, v214
  v_mul_f32 v224, v224, v214
  v_mul_f32 v223, v223, v214
  v_mul_f32 v225, v225, v214
  v_cvt_pk_bf16_f32 v202, v222, v223
  v_cvt_pk_bf16_f32 v203, v224, v225
  ds_write_b64 v226, v[202:203] offset:256
  v_lshlrev_b32 v222, 16, v204
  v_lshlrev_b32 v224, 16, v205
  v_and_b32 v223, v221, v204
  v_and_b32 v225, v221, v205
  v_sub_f32 v222, v222, v212
  v_sub_f32 v224, v224, v212
  v_sub_f32 v223, v223, v212
  v_sub_f32 v225, v225, v212
  v_cvt_pk_bf16_f32 v204, v222, v223
  v_cvt_pk_bf16_f32 v205, v224, v225
  v_lshlrev_b32 v222, 16, v204
  v_lshlrev_b32 v224, 16, v205
  v_and_b32 v223, v221, v204
  v_and_b32 v225, v221, v205
  v_mul_f32 v222, v222, v214
  v_mul_f32 v224, v224, v214
  v_mul_f32 v223, v223, v214
  v_mul_f32 v225, v225, v214
  v_cvt_pk_bf16_f32 v204, v222, v223
  v_cvt_pk_bf16_f32 v205, v224, v225
  ds_write_b64 v226, v[204:205] offset:512
  v_lshlrev_b32 v222, 16, v206
  v_lshlrev_b32 v224, 16, v207
  v_and_b32 v223, v221, v206
  v_and_b32 v225, v221, v207
  v_sub_f32 v222, v222, v212
  v_sub_f32 v224, v224, v212
  v_sub_f32 v223, v223, v212
  v_sub_f32 v225, v225, v212
  v_cvt_pk_bf16_f32 v206, v222, v223
  v_cvt_pk_bf16_f32 v207, v224, v225
  v_lshlrev_b32 v222, 16, v206
  v_lshlrev_b32 v224, 16, v207
  v_and_b32 v223, v221, v206
  v_and_b32 v225, v221, v207
  v_mul_f32 v222, v222, v214
  v_mul_f32 v224, v224, v214
  v_mul_f32 v223, v223, v214
  v_mul_f32 v225, v225, v214
  v_cvt_pk_bf16_f32 v206, v222, v223
  v_cvt_pk_bf16_f32 v207, v224, v225
  ds_write_b64 v226, v[206:207] offset:768
  v_lshlrev_b32 v222, 16, v208
  v_lshlrev_b32 v224, 16, v209
  v_and_b32 v223, v221, v208
  v_and_b32 v225, v221, v209
  v_sub_f32 v222, v222, v212
  v_sub_f32 v224, v224, v212
  v_sub_f32 v223, v223, v212
  v_sub_f32 v225, v225, v212
  v_cvt_pk_bf16_f32 v208, v222, v223
  v_cvt_pk_bf16_f32 v209, v224, v225
  v_lshlrev_b32 v222, 16, v208
  v_lshlrev_b32 v224, 16, v209
  v_and_b32 v223, v221, v208
  v_and_b32 v225, v221, v209
  v_mul_f32 v222, v222, v214
  v_mul_f32 v224, v224, v214
  v_mul_f32 v223, v223, v214
  v_mul_f32 v225, v225, v214
  v_cvt_pk_bf16_f32 v208, v222, v223
  v_cvt_pk_bf16_f32 v209, v224, v225
  ds_write_b64 v226, v[208:209] offset:1024
  s_waitcnt lgkmcnt(0)
  s_barrier
  s_lshl_b32 s22, s16, 1
  s_add_u32 s22, s22, s19
  s_cmp_eq_u32 s22, 27
  s_cbranch_scc1 G_SKIP
  ds_read_b64_tr_b16 v[96:97], v2 offset:0
  ds_read_b64_tr_b16 v[98:99], v2 offset:4096
  ds_read_b128 v[112:115], v8 offset:0
  ds_read_b64_tr_b16 v[100:101], v3 offset:0
  ds_read_b64_tr_b16 v[102:103], v3 offset:4096
  ds_read_b128 v[116:119], v8 offset:1024
  ds_read_b64_tr_b16 v[104:105], v4 offset:0
  ds_read_b64_tr_b16 v[106:107], v4 offset:4096
  ds_read_b128 v[120:123], v8 offset:2048
  ds_read_b64_tr_b16 v[108:109], v5 offset:0
  ds_read_b64_tr_b16 v[110:111], v5 offset:4096
  ds_read_b128 v[124:127], v8 offset:3072
  s_waitcnt lgkmcnt(0)
  v_mfma_f32_16x16x32_bf16 v[16:19], v[96:99], v[112:115], 0
  ds_read_b64_tr_b16 v[128:129], v2 offset:8192
  v_mfma_f32_16x16x32_bf16 v[32:35], v[96:99], v[116:119], 0
  ds_read_b64_tr_b16 v[130:131], v2 offset:12288
  v_mfma_f32_16x16x32_bf16 v[48:51], v[96:99], v[120:123], 0
  ds_read_b128 v[144:147], v9 offset:0
  v_mfma_f32_16x16x32_bf16 v[64:67], v[96:99], v[124:127], 0
  ds_read_b64_tr_b16 v[132:133], v3 offset:8192
  v_mfma_f32_16x16x32_bf16 v[80:83], v[160:163], v[96:99], 0
  ds_read_b64_tr_b16 v[134:135], v3 offset:12288
  v_mfma_f32_16x16x32_bf16 v[20:23], v[100:103], v[112:115], 0
  ds_read_b128 v[148:151], v9 offset:1024
  v_mfma_f32_16x16x32_bf16 v[36:39], v[100:103], v[116:119], 0
  ds_read_b64_tr_b16 v[136:137], v4 offset:8192
  v_mfma_f32_16x16x32_bf16 v[52:55], v[100:103], v[120:123], 0
  ds_read_b64_tr_b16 v[138:139], v4 offset:12288
  v_mfma_f32_16x16x32_bf16 v[68:71], v[100:103], v[124:127], 0
  ds_read_b128 v[152:155], v9 offset:2048
  v_mfma_f32_16x16x32_bf16 v[84:87], v[160:163], v[100:103], 0
  ds_read_b64_tr_b16 v[140:141], v5 offset:8192
  v_mfma_f32_16x16x32_bf16 v[24:27], v[104:107], v[112:115], 0
  ds_read_b64_tr_b16 v[142:143], v5 offset:12288
  v_mfma_f32_16x16x32_bf16 v[40:43], v[104:107], v[116:119], 0
  ds_read_b128 v[156:159], v9 offset:3072
  v_mfma_f32_16x16x32_bf16 v[56:59], v[104:107], v[120:123], 0
  v_mfma_f32_16x16x32_bf16 v[72:75], v[104:107], v[124:127], 0
  v_mfma_f32_16x16x32_bf16 v[88:91], v[160:163], v[104:107], 0
  v_mfma_f32_16x16x32_bf16 v[28:31], v[108:111], v[112:115], 0
  v_mfma_f32_16x16x32_bf16 v[44:47], v[108:111], v[116:119], 0
  v_mfma_f32_16x16x32_bf16 v[60:63], v[108:111], v[120:123], 0
  v_mfma_f32_16x16x32_bf16 v[76:79], v[108:111], v[124:127], 0
  v_mfma_f32_16x16x32_bf16 v[92:95], v[160:163], v[108:111], 0
  s_waitcnt lgkmcnt(0)
  s_barrier
  v_mfma_f32_16x16x32_bf16 v[16:19], v[128:131], v[144:147], v[16:19]
  ds_read_b64_tr_b16 v[96:97], v2 offset:32768
  v_mfma_f32_16x16x32_bf16 v[32:35], v[128:131], v[148:151], v[32:35]
  ds_read_b64_tr_b16 v[98:99], v2 offset:36864
  v_mfma_f32_16x16x32_bf16 v[48:51], v[128:131], v[152:155], v[48:51]
  ds_read_b128 v[112:115], v8 offset:32768
  v_mfma_f32_16x16x32_bf16 v[64:67], v[128:131], v[156:159], v[64:67]
  ds_read_b64_tr_b16 v[100:101], v3 offset:32768
  v_mfma_f32_16x16x32_bf16 v[80:83], v[160:163], v[128:131], v[80:83]
  ds_read_b64_tr_b16 v[102:103], v3 offset:36864
  v_mfma_f32_16x16x32_bf16 v[20:23], v[132:135], v[144:147], v[20:23]
  ds_read_b128 v[116:119], v8 offset:33792
  v_mfma_f32_16x16x32_bf16 v[36:39], v[132:135], v[148:151], v[36:39]
  ds_read_b64_tr_b16 v[104:105], v4 offset:32768
  v_mfma_f32_16x16x32_bf16 v[52:55], v[132:135], v[152:155], v[52:55]
  ds_read_b64_tr_b16 v[106:107], v4 offset:36864
  v_mfma_f32_16x16x32_bf16 v[68:71], v[132:135], v[156:159], v[68:71]
  ds_read_b128 v[120:123], v8 offset:34816
  v_mfma_f32_16x16x32_bf16 v[84:87], v[160:163], v[132:135], v[84:87]
  ds_read_b64_tr_b16 v[108:109], v5 offset:32768
  v_mfma_f32_16x16x32_bf16 v[24:27], v[136:139], v[144:147], v[24:27]
  ds_read_b64_tr_b16 v[110:111], v5 offset:36864
  v_mfma_f32_16x16x32_bf16 v[40:43], v[136:139], v[148:151], v[40:43]
  ds_read_b128 v[124:127], v8 offset:35840
  v_mfma_f32_16x16x32_bf16 v[56:59], v[136:139], v[152:155], v[56:59]
  v_mfma_f32_16x16x32_bf16 v[72:75], v[136:139], v[156:159], v[72:75]
  v_mfma_f32_16x16x32_bf16 v[88:91], v[160:163], v[136:139], v[88:91]
  v_mfma_f32_16x16x32_bf16 v[28:31], v[140:143], v[144:147], v[28:31]
  v_mfma_f32_16x16x32_bf16 v[44:47], v[140:143], v[148:151], v[44:47]
  v_mfma_f32_16x16x32_bf16 v[60:63], v[140:143], v[152:155], v[60:63]
  v_mfma_f32_16x16x32_bf16 v[76:79], v[140:143], v[156:159], v[76:79]
  v_mfma_f32_16x16x32_bf16 v[92:95], v[160:163], v[140:143], v[92:95]
  s_waitcnt lgkmcnt(0)
  v_mfma_f32_16x16x32_bf16 v[16:19], v[96:99], v[112:115], v[16:19]
  ds_read_b64_tr_b16 v[128:129], v2 offset:40960
  v_mfma_f32_16x16x32_bf16 v[32:35], v[96:99], v[116:119], v[32:35]
  ds_read_b64_tr_b16 v[130:131], v2 offset:45056
  v_mfma_f32_16x16x32_bf16 v[48:51], v[96:99], v[120:123], v[48:51]
  ds_read_b128 v[144:147], v9 offset:32768
  v_mfma_f32_16x16x32_bf16 v[64:67], v[96:99], v[124:127], v[64:67]
  ds_read_b64_tr_b16 v[132:133], v3 offset:40960
  v_mfma_f32_16x16x32_bf16 v[80:83], v[160:163], v[96:99], v[80:83]
  ds_read_b64_tr_b16 v[134:135], v3 offset:45056
  v_mfma_f32_16x16x32_bf16 v[20:23], v[100:103], v[112:115], v[20:23]
  ds_read_b128 v[148:151], v9 offset:33792
  v_mfma_f32_16x16x32_bf16 v[36:39], v[100:103], v[116:119], v[36:39]
  ds_read_b64_tr_b16 v[136:137], v4 offset:40960
  v_mfma_f32_16x16x32_bf16 v[52:55], v[100:103], v[120:123], v[52:55]
  ds_read_b64_tr_b16 v[138:139], v4 offset:45056
  v_mfma_f32_16x16x32_bf16 v[68:71], v[100:103], v[124:127], v[68:71]
  ds_read_b128 v[152:155], v9 offset:34816
  v_mfma_f32_16x16x32_bf16 v[84:87], v[160:163], v[100:103], v[84:87]
  ds_read_b64_tr_b16 v[140:141], v5 offset:40960
  v_mfma_f32_16x16x32_bf16 v[24:27], v[104:107], v[112:115], v[24:27]
  ds_read_b64_tr_b16 v[142:143], v5 offset:45056
  v_mfma_f32_16x16x32_bf16 v[40:43], v[104:107], v[116:119], v[40:43]
  ds_read_b128 v[156:159], v9 offset:35840
  v_mfma_f32_16x16x32_bf16 v[56:59], v[104:107], v[120:123], v[56:59]
  v_mfma_f32_16x16x32_bf16 v[72:75], v[104:107], v[124:127], v[72:75]
  v_mfma_f32_16x16x32_bf16 v[88:91], v[160:163], v[104:107], v[88:91]
  v_mfma_f32_16x16x32_bf16 v[28:31], v[108:111], v[112:115], v[28:31]
  v_mfma_f32_16x16x32_bf16 v[44:47], v[108:111], v[116:119], v[44:47]
  v_mfma_f32_16x16x32_bf16 v[60:63], v[108:111], v[120:123], v[60:63]
  v_mfma_f32_16x16x32_bf16 v[76:79], v[108:111], v[124:127], v[76:79]
  v_mfma_f32_16x16x32_bf16 v[92:95], v[160:163], v[108:111], v[92:95]
  s_waitcnt lgkmcnt(0)
  s_barrier
  v_mfma_f32_16x16x32_bf16 v[16:19], v[128:131], v[144:147], v[16:19]
  v_xor_b32 v2, 0x10000, v2
  v_xor_b32 v8, 0x10000, v8
  v_mfma_f32_16x16x32_bf16 v[32:35], v[128:131], v[148:151], v[32:35]
  v_xor_b32 v3, 0x10000, v3
  v_xor_b32 v4, 0x10000, v4
  v_mfma_f32_16x16x32_bf16 v[48:51], v[128:131], v[152:155], v[48:51]
  v_xor_b32 v5, 0x10000, v5
  v_xor_b32 v9, 0x10000, v9
  v_mfma_f32_16x16x32_bf16 v[64:67], v[128:131], v[156:159], v[64:67]
  ds_read_b64_tr_b16 v[96:97], v2 offset:0
  v_mfma_f32_16x16x32_bf16 v[80:83], v[160:163], v[128:131], v[80:83]
  ds_read_b64_tr_b16 v[98:99], v2 offset:4096
  v_mfma_f32_16x16x32_bf16 v[20:23], v[132:135], v[144:147], v[20:23]
  ds_read_b128 v[112:115], v8 offset:0
  v_mfma_f32_16x16x32_bf16 v[36:39], v[132:135], v[148:151], v[36:39]
  ds_read_b64_tr_b16 v[100:101], v3 offset:0
  v_mfma_f32_16x16x32_bf16 v[52:55], v[132:135], v[152:155], v[52:55]
  ds_read_b64_tr_b16 v[102:103], v3 offset:4096
  v_mfma_f32_16x16x32_bf16 v[68:71], v[132:135], v[156:159], v[68:71]
  ds_read_b128 v[116:119], v8 offset:1024
  v_mfma_f32_16x16x32_bf16 v[84:87], v[160:163], v[132:135], v[84:87]
  ds_read_b64_tr_b16 v[104:105], v4 offset:0
  v_mfma_f32_16x16x32_bf16 v[24:27], v[136:139], v[144:147], v[24:27]
  ds_read_b64_tr_b16 v[106:107], v4 offset:4096
  v_mfma_f32_16x16x32_bf16 v[40:43], v[136:139], v[148:151], v[40:43]
  ds_read_b128 v[120:123], v8 offset:2048
  v_mfma_f32_16x16x32_bf16 v[56:59], v[136:139], v[152:155], v[56:59]
  ds_read_b64_tr_b16 v[108:109], v5 offset:0
  v_mfma_f32_16x16x32_bf16 v[72:75], v[136:139], v[156:159], v[72:75]
  ds_read_b64_tr_b16 v[110:111], v5 offset:4096
  v_mfma_f32_16x16x32_bf16 v[88:91], v[160:163], v[136:139], v[88:91]
  ds_read_b128 v[124:127], v8 offset:3072
  v_mfma_f32_16x16x32_bf16 v[28:31], v[140:143], v[144:147], v[28:31]
  v_mfma_f32_16x16x32_bf16 v[44:47], v[140:143], v[148:151], v[44:47]
  v_mfma_f32_16x16x32_bf16 v[60:63], v[140:143], v[152:155], v[60:63]
  v_mfma_f32_16x16x32_bf16 v[76:79], v[140:143], v[156:159], v[76:79]
  v_mfma_f32_16x16x32_bf16 v[92:95], v[160:163], v[140:143], v[92:95]
  s_waitcnt lgkmcnt(0)
  v_mfma_f32_16x16x32_bf16 v[16:19], v[96:99], v[112:115], v[16:19]
  ds_read_b64_tr_b16 v[128:129], v2 offset:8192
  v_mfma_f32_16x16x32_bf16 v[32:35], v[96:99], v[116:119], v[32:35]
  ds_read_b64_tr_b16 v[130:131], v2 offset:12288
  v_mfma_f32_16x16x32_bf16 v[48:51], v[96:99], v[120:123], v[48:51]
  ds_read_b128 v[144:147], v9 offset:0
  v_mfma_f32_16x16x32_bf16 v[64:67], v[96:99], v[124:127], v[64:67]
  ds_read_b64_tr_b16 v[132:133], v3 offset:8192
  v_mfma_f32_16x16x32_bf16 v[80:83], v[160:163], v[96:99], v[80:83]
  ds_read_b64_tr_b16 v[134:135], v3 offset:12288
  v_mfma_f32_16x16x32_bf16 v[20:23], v[100:103], v[112:115], v[20:23]
  ds_read_b128 v[148:151], v9 offset:1024
  v_mfma_f32_16x16x32_bf16 v[36:39], v[100:103], v[116:119], v[36:39]
  ds_read_b64_tr_b16 v[136:137], v4 offset:8192
  v_mfma_f32_16x16x32_bf16 v[52:55], v[100:103], v[120:123], v[52:55]
  ds_read_b64_tr_b16 v[138:139], v4 offset:12288
  v_mfma_f32_16x16x32_bf16 v[68:71], v[100:103], v[124:127], v[68:71]
  ds_read_b128 v[152:155], v9 offset:2048
  v_mfma_f32_16x16x32_bf16 v[84:87], v[160:163], v[100:103], v[84:87]
  ds_read_b64_tr_b16 v[140:141], v5 offset:8192
  v_mfma_f32_16x16x32_bf16 v[24:27], v[104:107], v[112:115], v[24:27]
  ds_read_b64_tr_b16 v[142:143], v5 offset:12288
  v_mfma_f32_16x16x32_bf16 v[40:43], v[104:107], v[116:119], v[40:43]
  ds_read_b128 v[156:159], v9 offset:3072
  v_mfma_f32_16x16x32_bf16 v[56:59], v[104:107], v[120:123], v[56:59]
  v_mfma_f32_16x16x32_bf16 v[72:75], v[104:107], v[124:127], v[72:75]
  v_mfma_f32_16x16x32_bf16 v[88:91], v[160:163], v[104:107], v[88:91]
  v_mfma_f32_16x16x32_bf16 v[28:31], v[108:111], v[112:115], v[28:31]
  v_mfma_f32_16x16x32_bf16 v[44:47], v[108:111], v[116:119], v[44:47]
  v_mfma_f32_16x16x32_bf16 v[60:63], v[108:111], v[120:123], v[60:63]
  v_mfma_f32_16x16x32_bf16 v[76:79], v[108:111], v[124:127], v[76:79]
  v_mfma_f32_16x16x32_bf16 v[92:95], v[160:163], v[108:111], v[92:95]
  s_waitcnt lgkmcnt(0)
  s_barrier
  v_mfma_f32_16x16x32_bf16 v[16:19], v[128:131], v[144:147], v[16:19]
  v_xor_b32 v2, 0x10000, v2
  v_xor_b32 v8, 0x10000, v8
  v_mfma_f32_16x16x32_bf16 v[32:35], v[128:131], v[148:151], v[32:35]
  v_xor_b32 v3, 0x10000, v3
  v_xor_b32 v4, 0x10000, v4
  v_mfma_f32_16x16x32_bf16 v[48:51], v[128:131], v[152:155], v[48:51]
  v_xor_b32 v5, 0x10000, v5
  v_xor_b32 v9, 0x10000, v9
  v_mfma_f32_16x16x32_bf16 v[64:67], v[128:131], v[156:159], v[64:67]
  ds_read_b64_tr_b16 v[96:97], v2 offset:0
  v_mfma_f32_16x16x32_bf16 v[80:83], v[160:163], v[128:131], v[80:83]
  ds_read_b64_tr_b16 v[98:99], v2 offset:4096
  v_mfma_f32_16x16x32_bf16 v[20:23], v[132:135], v[144:147], v[20:23]
  ds_read_b128 v[112:115], v8 offset:0
  v_mfma_f32_16x16x32_bf16 v[36:39], v[132:135], v[148:151], v[36:39]
  ds_read_b64_tr_b16 v[100:101], v3 offset:0
  v_mfma_f32_16x16x32_bf16 v[52:55], v[132:135], v[152:155], v[52:55]
  ds_read_b64_tr_b16 v[102:103], v3 offset:4096
  v_mfma_f32_16x16x32_bf16 v[68:71], v[132:135], v[156:159], v[68:71]
  ds_read_b128 v[116:119], v8 offset:1024
  v_mfma_f32_16x16x32_bf16 v[84:87], v[160:163], v[132:135], v[84:87]
  ds_read_b64_tr_b16 v[104:105], v4 offset:0
  v_mfma_f32_16x16x32_bf16 v[24:27], v[136:139], v[144:147], v[24:27]
  ds_read_b64_tr_b16 v[106:107], v4 offset:4096
  v_mfma_f32_16x16x32_bf16 v[40:43], v[136:139], v[148:151], v[40:43]
  ds_read_b128 v[120:123], v8 offset:2048
  v_mfma_f32_16x16x32_bf16 v[56:59], v[136:139], v[152:155], v[56:59]
  ds_read_b64_tr_b16 v[108:109], v5 offset:0
  v_mfma_f32_16x16x32_bf16 v[72:75], v[136:139], v[156:159], v[72:75]
  ds_read_b64_tr_b16 v[110:111], v5 offset:4096
  v_mfma_f32_16x16x32_bf16 v[88:91], v[160:163], v[136:139], v[88:91]
  ds_read_b128 v[124:127], v8 offset:3072
  v_mfma_f32_16x16x32_bf16 v[28:31], v[140:143], v[144:147], v[28:31]
  v_mfma_f32_16x16x32_bf16 v[44:47], v[140:143], v[148:151], v[44:47]
  v_mfma_f32_16x16x32_bf16 v[60:63], v[140:143], v[152:155], v[60:63]
  v_mfma_f32_16x16x32_bf16 v[76:79], v[140:143], v[156:159], v[76:79]
  v_mfma_f32_16x16x32_bf16 v[92:95], v[160:163], v[140:143], v[92:95]
  s_waitcnt lgkmcnt(0)
  v_mfma_f32_16x16x32_bf16 v[16:19], v[96:99], v[112:115], v[16:19]
  ds_read_b64_tr_b16 v[128:129], v2 offset:8192
  v_mfma_f32_16x16x32_bf16 v[32:35], v[96:99], v[116:119], v[32:35]
  ds_read_b64_tr_b16 v[130:131], v2 offset:12288
  v_mfma_f32_16x16x32_bf16 v[48:51], v[96:99], v[120:123], v[48:51]
  ds_read_b128 v[144:147], v9 offset:0
  v_mfma_f32_16x16x32_bf16 v[64:67], v[96:99], v[124:127], v[64:67]
  ds_read_b64_tr_b16 v[132:133], v3 offset:8192
  v_mfma_f32_16x16x32_bf16 v[80:83], v[160:163], v[96:99], v[80:83]
  ds_read_b64_tr_b16 v[134:135], v3 offset:12288
  v_mfma_f32_16x16x32_bf16 v[20:23], v[100:103], v[112:115], v[20:23]
  ds_read_b128 v[148:151], v9 offset:1024
  v_mfma_f32_16x16x32_bf16 v[36:39], v[100:103], v[116:119], v[36:39]
  ds_read_b64_tr_b16 v[136:137], v4 offset:8192
  v_mfma_f32_16x16x32_bf16 v[52:55], v[100:103], v[120:123], v[52:55]
  ds_read_b64_tr_b16 v[138:139], v4 offset:12288
  v_mfma_f32_16x16x32_bf16 v[68:71], v[100:103], v[124:127], v[68:71]
  ds_read_b128 v[152:155], v9 offset:2048
  v_mfma_f32_16x16x32_bf16 v[84:87], v[160:163], v[100:103], v[84:87]
  ds_read_b64_tr_b16 v[140:141], v5 offset:8192
  v_mfma_f32_16x16x32_bf16 v[24:27], v[104:107], v[112:115], v[24:27]
  ds_read_b64_tr_b16 v[142:143], v5 offset:12288
  v_mfma_f32_16x16x32_bf16 v[40:43], v[104:107], v[116:119], v[40:43]
  ds_read_b128 v[156:159], v9 offset:3072
  v_mfma_f32_16x16x32_bf16 v[56:59], v[104:107], v[120:123], v[56:59]
  v_mfma_f32_16x16x32_bf16 v[72:75], v[104:107], v[124:127], v[72:75]
  v_mfma_f32_16x16x32_bf16 v[88:91], v[160:163], v[104:107], v[88:91]
  v_mfma_f32_16x16x32_bf16 v[28:31], v[108:111], v[112:115], v[28:31]
  v_mfma_f32_16x16x32_bf16 v[44:47], v[108:111], v[116:119], v[44:47]
  v_mfma_f32_16x16x32_bf16 v[60:63], v[108:111], v[120:123], v[60:63]
  v_mfma_f32_16x16x32_bf16 v[76:79], v[108:111], v[124:127], v[76:79]
  v_mfma_f32_16x16x32_bf16 v[92:95], v[160:163], v[108:111], v[92:95]
  s_waitcnt lgkmcnt(0)
  s_barrier
  v_mfma_f32_16x16x32_bf16 v[16:19], v[128:131], v[144:147], v[16:19]
  ds_read_b64_tr_b16 v[96:97], v2 offset:32768
  v_mfma_f32_16x16x32_bf16 v[32:35], v[128:131], v[148:151], v[32:35]
  ds_read_b64_tr_b16 v[98:99], v2 offset:36864
  v_mfma_f32_16x16x32_bf16 v[48:51], v[128:131], v[152:155], v[48:51]
  ds_read_b128 v[112:115], v8 offset:32768
  v_mfma_f32_16x16x32_bf16 v[64:67], v[128:131], v[156:159], v[64:67]
  ds_read_b64_tr_b16 v[100:101], v3 offset:32768
  v_mfma_f32_16x16x32_bf16 v[80:83], v[160:163], v[128:131], v[80:83]
  ds_read_b64_tr_b16 v[102:103], v3 offset:36864
  v_mfma_f32_16x16x32_bf16 v[20:23], v[132:135], v[144:147], v[20:23]
  ds_read_b128 v[116:119], v8 offset:33792
  v_mfma_f32_16x16x32_bf16 v[36:39], v[132:135], v[148:151], v[36:39]
  ds_read_b64_tr_b16 v[104:105], v4 offset:32768
  v_mfma_f32_16x16x32_bf16 v[52:55], v[132:135], v[152:155], v[52:55]
  ds_read_b64_tr_b16 v[106:107], v4 offset:36864
  v_mfma_f32_16x16x32_bf16 v[68:71], v[132:135], v[156:159], v[68:71]
  ds_read_b128 v[120:123], v8 offset:34816
  v_mfma_f32_16x16x32_bf16 v[84:87], v[160:163], v[132:135], v[84:87]
  ds_read_b64_tr_b16 v[108:109], v5 offset:32768
  v_mfma_f32_16x16x32_bf16 v[24:27], v[136:139], v[144:147], v[24:27]
  ds_read_b64_tr_b16 v[110:111], v5 offset:36864
  v_mfma_f32_16x16x32_bf16 v[40:43], v[136:139], v[148:151], v[40:43]
  ds_read_b128 v[124:127], v8 offset:35840
  v_mfma_f32_16x16x32_bf16 v[56:59], v[136:139], v[152:155], v[56:59]
  v_mfma_f32_16x16x32_bf16 v[72:75], v[136:139], v[156:159], v[72:75]
  v_mfma_f32_16x16x32_bf16 v[88:91], v[160:163], v[136:139], v[88:91]
  v_mfma_f32_16x16x32_bf16 v[28:31], v[140:143], v[144:147], v[28:31]
  v_mfma_f32_16x16x32_bf16 v[44:47], v[140:143], v[148:151], v[44:47]
  v_mfma_f32_16x16x32_bf16 v[60:63], v[140:143], v[152:155], v[60:63]
  v_mfma_f32_16x16x32_bf16 v[76:79], v[140:143], v[156:159], v[76:79]
  v_mfma_f32_16x16x32_bf16 v[92:95], v[160:163], v[140:143], v[92:95]
  s_waitcnt lgkmcnt(0)
  v_mfma_f32_16x16x32_bf16 v[16:19], v[96:99], v[112:115], v[16:19]
  ds_read_b64_tr_b16 v[128:129], v2 offset:40960
  v_mfma_f32_16x16x32_bf16 v[32:35], v[96:99], v[116:119], v[32:35]
  ds_read_b64_tr_b16 v[130:131], v2 offset:45056
  v_mfma_f32_16x16x32_bf16 v[48:51], v[96:99], v[120:123], v[48:51]
  ds_read_b128 v[144:147], v9 offset:32768
  v_mfma_f32_16x16x32_bf16 v[64:67], v[96:99], v[124:127], v[64:67]
  ds_read_b64_tr_b16 v[132:133], v3 offset:40960
  v_mfma_f32_16x16x32_bf16 v[80:83], v[160:163], v[96:99], v[80:83]
  ds_read_b64_tr_b16 v[134:135], v3 offset:45056
  v_mfma_f32_16x16x32_bf16 v[20:23], v[100:103], v[112:115], v[20:23]
  ds_read_b128 v[148:151], v9 offset:33792
  v_mfma_f32_16x16x32_bf16 v[36:39], v[100:103], v[116:119], v[36:39]
  ds_read_b64_tr_b16 v[136:137], v4 offset:40960
  v_mfma_f32_16x16x32_bf16 v[52:55], v[100:103], v[120:123], v[52:55]
  ds_read_b64_tr_b16 v[138:139], v4 offset:45056
  v_mfma_f32_16x16x32_bf16 v[68:71], v[100:103], v[124:127], v[68:71]
  ds_read_b128 v[152:155], v9 offset:34816
  v_mfma_f32_16x16x32_bf16 v[84:87], v[160:163], v[100:103], v[84:87]
  ds_read_b64_tr_b16 v[140:141], v5 offset:40960
  v_mfma_f32_16x16x32_bf16 v[24:27], v[104:107], v[112:115], v[24:27]
  ds_read_b64_tr_b16 v[142:143], v5 offset:45056
  v_mfma_f32_16x16x32_bf16 v[40:43], v[104:107], v[116:119], v[40:43]
  ds_read_b128 v[156:159], v9 offset:35840
  v_mfma_f32_16x16x32_bf16 v[56:59], v[104:107], v[120:123], v[56:59]
  v_mfma_f32_16x16x32_bf16 v[72:75], v[104:107], v[124:127], v[72:75]
  v_mfma_f32_16x16x32_bf16 v[88:91], v[160:163], v[104:107], v[88:91]
  v_mfma_f32_16x16x32_bf16 v[28:31], v[108:111], v[112:115], v[28:31]
  v_mfma_f32_16x16x32_bf16 v[44:47], v[108:111], v[116:119], v[44:47]
  v_mfma_f32_16x16x32_bf16 v[60:63], v[108:111], v[120:123], v[60:63]
  v_mfma_f32_16x16x32_bf16 v[76:79], v[108:111], v[124:127], v[76:79]
  v_mfma_f32_16x16x32_bf16 v[92:95], v[160:163], v[108:111], v[92:95]
  s_waitcnt lgkmcnt(0)
  s_barrier
  v_mfma_f32_16x16x32_bf16 v[16:19], v[128:131], v[144:147], v[16:19]
  v_xor_b32 v2, 0x10000, v2
  v_xor_b32 v8, 0x10000, v8
  v_mfma_f32_16x16x32_bf16 v[32:35], v[128:131], v[148:151], v[32:35]
  v_xor_b32 v3, 0x10000, v3
  v_xor_b32 v4, 0x10000, v4
  v_mfma_f32_16x16x32_bf16 v[48:51], v[128:131], v[152:155], v[48:51]
  v_xor_b32 v5, 0x10000, v5
  v_xor_b32 v9, 0x10000, v9
  v_mfma_f32_16x16x32_bf16 v[64:67], v[128:131], v[156:159], v[64:67]
  ds_read_b64_tr_b16 v[96:97], v2 offset:0
  v_mfma_f32_16x16x32_bf16 v[80:83], v[160:163], v[128:131], v[80:83]
  ds_read_b64_tr_b16 v[98:99], v2 offset:4096
  v_mfma_f32_16x16x32_bf16 v[20:23], v[132:135], v[144:147], v[20:23]
  ds_read_b128 v[112:115], v8 offset:0
  v_mfma_f32_16x16x32_bf16 v[36:39], v[132:135], v[148:151], v[36:39]
  ds_read_b64_tr_b16 v[100:101], v3 offset:0
  v_mfma_f32_16x16x32_bf16 v[52:55], v[132:135], v[152:155], v[52:55]
  ds_read_b64_tr_b16 v[102:103], v3 offset:4096
  v_mfma_f32_16x16x32_bf16 v[68:71], v[132:135], v[156:159], v[68:71]
  ds_read_b128 v[116:119], v8 offset:1024
  v_mfma_f32_16x16x32_bf16 v[84:87], v[160:163], v[132:135], v[84:87]
  ds_read_b64_tr_b16 v[104:105], v4 offset:0
  v_mfma_f32_16x16x32_bf16 v[24:27], v[136:139], v[144:147], v[24:27]
  ds_read_b64_tr_b16 v[106:107], v4 offset:4096
  v_mfma_f32_16x16x32_bf16 v[40:43], v[136:139], v[148:151], v[40:43]
  ds_read_b128 v[120:123], v8 offset:2048
  v_mfma_f32_16x16x32_bf16 v[56:59], v[136:139], v[152:155], v[56:59]
  ds_read_b64_tr_b16 v[108:109], v5 offset:0
  v_mfma_f32_16x16x32_bf16 v[72:75], v[136:139], v[156:159], v[72:75]
  ds_read_b64_tr_b16 v[110:111], v5 offset:4096
  v_mfma_f32_16x16x32_bf16 v[88:91], v[160:163], v[136:139], v[88:91]
  ds_read_b128 v[124:127], v8 offset:3072
  v_mfma_f32_16x16x32_bf16 v[28:31], v[140:143], v[144:147], v[28:31]
  v_mfma_f32_16x16x32_bf16 v[44:47], v[140:143], v[148:151], v[44:47]
  v_mfma_f32_16x16x32_bf16 v[60:63], v[140:143], v[152:155], v[60:63]
  v_mfma_f32_16x16x32_bf16 v[76:79], v[140:143], v[156:159], v[76:79]
  v_mfma_f32_16x16x32_bf16 v[92:95], v[160:163], v[140:143], v[92:95]
  s_waitcnt lgkmcnt(0)
  v_mfma_f32_16x16x32_bf16 v[16:19], v[96:99], v[112:115], v[16:19]
  ds_read_b64_tr_b16 v[128:129], v2 offset:8192
  v_mfma_f32_16x16x32_bf16 v[32:35], v[96:99], v[116:119], v[32:35]
  ds_read_b64_tr_b16 v[130:131], v2 offset:12288
  v_mfma_f32_16x16x32_bf16 v[48:51], v[96:99], v[120:123], v[48:51]
  ds_read_b128 v[144:147], v9 offset:0
  v_mfma_f32_16x16x32_bf16 v[64:67], v[96:99], v[124:127], v[64:67]
  ds_read_b64_tr_b16 v[132:133], v3 offset:8192
  v_mfma_f32_16x16x32_bf16 v[80:83], v[160:163], v[96:99], v[80:83]
  ds_read_b64_tr_b16 v[134:135], v3 offset:12288
  v_mfma_f32_16x16x32_bf16 v[20:23], v[100:103], v[112:115], v[20:23]
  ds_read_b128 v[148:151], v9 offset:1024
  v_mfma_f32_16x16x32_bf16 v[36:39], v[100:103], v[116:119], v[36:39]
  ds_read_b64_tr_b16 v[136:137], v4 offset:8192
  v_mfma_f32_16x16x32_bf16 v[52:55], v[100:103], v[120:123], v[52:55]
  ds_read_b64_tr_b16 v[138:139], v4 offset:12288
  v_mfma_f32_16x16x32_bf16 v[68:71], v[100:103], v[124:127], v[68:71]
  ds_read_b128 v[152:155], v9 offset:2048
  v_mfma_f32_16x16x32_bf16 v[84:87], v[160:163], v[100:103], v[84:87]
  ds_read_b64_tr_b16 v[140:141], v5 offset:8192
  v_mfma_f32_16x16x32_bf16 v[24:27], v[104:107], v[112:115], v[24:27]
  ds_read_b64_tr_b16 v[142:143], v5 offset:12288
  v_mfma_f32_16x16x32_bf16 v[40:43], v[104:107], v[116:119], v[40:43]
  ds_read_b128 v[156:159], v9 offset:3072
  v_mfma_f32_16x16x32_bf16 v[56:59], v[104:107], v[120:123], v[56:59]
  v_mfma_f32_16x16x32_bf16 v[72:75], v[104:107], v[124:127], v[72:75]
  v_mfma_f32_16x16x32_bf16 v[88:91], v[160:163], v[104:107], v[88:91]
  v_mfma_f32_16x16x32_bf16 v[28:31], v[108:111], v[112:115], v[28:31]
  v_mfma_f32_16x16x32_bf16 v[44:47], v[108:111], v[116:119], v[44:47]
  v_mfma_f32_16x16x32_bf16 v[60:63], v[108:111], v[120:123], v[60:63]
  v_mfma_f32_16x16x32_bf16 v[76:79], v[108:111], v[124:127], v[76:79]
  v_mfma_f32_16x16x32_bf16 v[92:95], v[160:163], v[108:111], v[92:95]
  s_waitcnt lgkmcnt(0)
  s_barrier
  v_mfma_f32_16x16x32_bf16 v[16:19], v[128:131], v[144:147], v[16:19]
  v_xor_b32 v2, 0x10000, v2
  v_xor_b32 v8, 0x10000, v8
  v_mfma_f32_16x16x32_bf16 v[32:35], v[128:131], v[148:151], v[32:35]
  v_xor_b32 v3, 0x10000, v3
  v_xor_b32 v4, 0x10000, v4
  v_mfma_f32_16x16x32_bf16 v[48:51], v[128:131], v[152:155], v[48:51]
  v_xor_b32 v5, 0x10000, v5
  v_xor_b32 v9, 0x10000, v9
  v_mfma_f32_16x16x32_bf16 v[64:67], v[128:131], v[156:159], v[64:67]
  ds_read_b64_tr_b16 v[96:97], v2 offset:0
  v_mfma_f32_16x16x32_bf16 v[80:83], v[160:163], v[128:131], v[80:83]
  ds_read_b64_tr_b16 v[98:99], v2 offset:4096
  v_mfma_f32_16x16x32_bf16 v[20:23], v[132:135], v[144:147], v[20:23]
  ds_read_b128 v[112:115], v8 offset:0
  v_mfma_f32_16x16x32_bf16 v[36:39], v[132:135], v[148:151], v[36:39]
  ds_read_b64_tr_b16 v[100:101], v3 offset:0
  v_mfma_f32_16x16x32_bf16 v[52:55], v[132:135], v[152:155], v[52:55]
  ds_read_b64_tr_b16 v[102:103], v3 offset:4096
  v_mfma_f32_16x16x32_bf16 v[68:71], v[132:135], v[156:159], v[68:71]
  ds_read_b128 v[116:119], v8 offset:1024
  v_mfma_f32_16x16x32_bf16 v[84:87], v[160:163], v[132:135], v[84:87]
  ds_read_b64_tr_b16 v[104:105], v4 offset:0
  v_mfma_f32_16x16x32_bf16 v[24:27], v[136:139], v[144:147], v[24:27]
  ds_read_b64_tr_b16 v[106:107], v4 offset:4096
  v_mfma_f32_16x16x32_bf16 v[40:43], v[136:139], v[148:151], v[40:43]
  ds_read_b128 v[120:123], v8 offset:2048
  v_mfma_f32_16x16x32_bf16 v[56:59], v[136:139], v[152:155], v[56:59]
  ds_read_b64_tr_b16 v[108:109], v5 offset:0
  v_mfma_f32_16x16x32_bf16 v[72:75], v[136:139], v[156:159], v[72:75]
  ds_read_b64_tr_b16 v[110:111], v5 offset:4096
  v_mfma_f32_16x16x32_bf16 v[88:91], v[160:163], v[136:139], v[88:91]
  ds_read_b128 v[124:127], v8 offset:3072
  v_mfma_f32_16x16x32_bf16 v[28:31], v[140:143], v[144:147], v[28:31]
  v_mfma_f32_16x16x32_bf16 v[44:47], v[140:143], v[148:151], v[44:47]
  v_mfma_f32_16x16x32_bf16 v[60:63], v[140:143], v[152:155], v[60:63]
  v_mfma_f32_16x16x32_bf16 v[76:79], v[140:143], v[156:159], v[76:79]
  v_mfma_f32_16x16x32_bf16 v[92:95], v[160:163], v[140:143], v[92:95]
  s_waitcnt lgkmcnt(0)
  v_mfma_f32_16x16x32_bf16 v[16:19], v[96:99], v[112:115], v[16:19]
  ds_read_b64_tr_b16 v[128:129], v2 offset:8192
  v_mfma_f32_16x16x32_bf16 v[32:35], v[96:99], v[116:119], v[32:35]
  ds_read_b64_tr_b16 v[130:131], v2 offset:12288
  v_mfma_f32_16x16x32_bf16 v[48:51], v[96:99], v[120:123], v[48:51]
  ds_read_b128 v[144:147], v9 offset:0
  v_mfma_f32_16x16x32_bf16 v[64:67], v[96:99], v[124:127], v[64:67]
  ds_read_b64_tr_b16 v[132:133], v3 offset:8192
  v_mfma_f32_16x16x32_bf16 v[80:83], v[160:163], v[96:99], v[80:83]
  ds_read_b64_tr_b16 v[134:135], v3 offset:12288
  v_mfma_f32_16x16x32_bf16 v[20:23], v[100:103], v[112:115], v[20:23]
  ds_read_b128 v[148:151], v9 offset:1024
  v_mfma_f32_16x16x32_bf16 v[36:39], v[100:103], v[116:119], v[36:39]
  ds_read_b64_tr_b16 v[136:137], v4 offset:8192
  v_mfma_f32_16x16x32_bf16 v[52:55], v[100:103], v[120:123], v[52:55]
  ds_read_b64_tr_b16 v[138:139], v4 offset:12288
  v_mfma_f32_16x16x32_bf16 v[68:71], v[100:103], v[124:127], v[68:71]
  ds_read_b128 v[152:155], v9 offset:2048
  v_mfma_f32_16x16x32_bf16 v[84:87], v[160:163], v[100:103], v[84:87]
  ds_read_b64_tr_b16 v[140:141], v5 offset:8192
  v_mfma_f32_16x16x32_bf16 v[24:27], v[104:107], v[112:115], v[24:27]
  ds_read_b64_tr_b16 v[142:143], v5 offset:12288
  v_mfma_f32_16x16x32_bf16 v[40:43], v[104:107], v[116:119], v[40:43]
  ds_read_b128 v[156:159], v9 offset:3072
  v_mfma_f32_16x16x32_bf16 v[56:59], v[104:107], v[120:123], v[56:59]
  v_mfma_f32_16x16x32_bf16 v[72:75], v[104:107], v[124:127], v[72:75]
  v_mfma_f32_16x16x32_bf16 v[88:91], v[160:163], v[104:107], v[88:91]
  v_mfma_f32_16x16x32_bf16 v[28:31], v[108:111], v[112:115], v[28:31]
  v_mfma_f32_16x16x32_bf16 v[44:47], v[108:111], v[116:119], v[44:47]
  v_mfma_f32_16x16x32_bf16 v[60:63], v[108:111], v[120:123], v[60:63]
  v_mfma_f32_16x16x32_bf16 v[76:79], v[108:111], v[124:127], v[76:79]
  v_mfma_f32_16x16x32_bf16 v[92:95], v[160:163], v[108:111], v[92:95]
  s_waitcnt lgkmcnt(0)
  s_barrier
  v_mfma_f32_16x16x32_bf16 v[16:19], v[128:131], v[144:147], v[16:19]
  ds_read_b64_tr_b16 v[96:97], v2 offset:32768
  v_mfma_f32_16x16x32_bf16 v[32:35], v[128:131], v[148:151], v[32:35]
  ds_read_b64_tr_b16 v[98:99], v2 offset:36864
  v_mfma_f32_16x16x32_bf16 v[48:51], v[128:131], v[152:155], v[48:51]
  ds_read_b128 v[112:115], v8 offset:32768
  v_mfma_f32_16x16x32_bf16 v[64:67], v[128:131], v[156:159], v[64:67]
  ds_read_b64_tr_b16 v[100:101], v3 offset:32768
  v_mfma_f32_16x16x32_bf16 v[80:83], v[160:163], v[128:131], v[80:83]
  ds_read_b64_tr_b16 v[102:103], v3 offset:36864
  v_mfma_f32_16x16x32_bf16 v[20:23], v[132:135], v[144:147], v[20:23]
  ds_read_b128 v[116:119], v8 offset:33792
  v_mfma_f32_16x16x32_bf16 v[36:39], v[132:135], v[148:151], v[36:39]
  ds_read_b64_tr_b16 v[104:105], v4 offset:32768
  v_mfma_f32_16x16x32_bf16 v[52:55], v[132:135], v[152:155], v[52:55]
  ds_read_b64_tr_b16 v[106:107], v4 offset:36864
  v_mfma_f32_16x16x32_bf16 v[68:71], v[132:135], v[156:159], v[68:71]
  ds_read_b128 v[120:123], v8 offset:34816
  v_mfma_f32_16x16x32_bf16 v[84:87], v[160:163], v[132:135], v[84:87]
  ds_read_b64_tr_b16 v[108:109], v5 offset:32768
  v_mfma_f32_16x16x32_bf16 v[24:27], v[136:139], v[144:147], v[24:27]
  ds_read_b64_tr_b16 v[110:111], v5 offset:36864
  v_mfma_f32_16x16x32_bf16 v[40:43], v[136:139], v[148:151], v[40:43]
  ds_read_b128 v[124:127], v8 offset:35840
  v_mfma_f32_16x16x32_bf16 v[56:59], v[136:139], v[152:155], v[56:59]
  v_mfma_f32_16x16x32_bf16 v[72:75], v[136:139], v[156:159], v[72:75]
  v_mfma_f32_16x16x32_bf16 v[88:91], v[160:163], v[136:139], v[88:91]
  v_mfma_f32_16x16x32_bf16 v[28:31], v[140:143], v[144:147], v[28:31]
  v_mfma_f32_16x16x32_bf16 v[44:47], v[140:143], v[148:151], v[44:47]
  v_mfma_f32_16x16x32_bf16 v[60:63], v[140:143], v[152:155], v[60:63]
  v_mfma_f32_16x16x32_bf16 v[76:79], v[140:143], v[156:159], v[76:79]
  v_mfma_f32_16x16x32_bf16 v[92:95], v[160:163], v[140:143], v[92:95]
  s_waitcnt lgkmcnt(0)
  v_mfma_f32_16x16x32_bf16 v[16:19], v[96:99], v[112:115], v[16:19]
  ds_read_b64_tr_b16 v[128:129], v2 offset:40960
  v_mfma_f32_16x16x32_bf16 v[32:35], v[96:99], v[116:119], v[32:35]
  ds_read_b64_tr_b16 v[130:131], v2 offset:45056
  v_mfma_f32_16x16x32_bf16 v[48:51], v[96:99], v[120:123], v[48:51]
  ds_read_b128 v[144:147], v9 offset:32768
  v_mfma_f32_16x16x32_bf16 v[64:67], v[96:99], v[124:127], v[64:67]
  ds_read_b64_tr_b16 v[132:133], v3 offset:40960
  v_mfma_f32_16x16x32_bf16 v[80:83], v[160:163], v[96:99], v[80:83]
  ds_read_b64_tr_b16 v[134:135], v3 offset:45056
  v_mfma_f32_16x16x32_bf16 v[20:23], v[100:103], v[112:115], v[20:23]
  ds_read_b128 v[148:151], v9 offset:33792
  v_mfma_f32_16x16x32_bf16 v[36:39], v[100:103], v[116:119], v[36:39]
  ds_read_b64_tr_b16 v[136:137], v4 offset:40960
  v_mfma_f32_16x16x32_bf16 v[52:55], v[100:103], v[120:123], v[52:55]
  ds_read_b64_tr_b16 v[138:139], v4 offset:45056
  v_mfma_f32_16x16x32_bf16 v[68:71], v[100:103], v[124:127], v[68:71]
  ds_read_b128 v[152:155], v9 offset:34816
  v_mfma_f32_16x16x32_bf16 v[84:87], v[160:163], v[100:103], v[84:87]
  ds_read_b64_tr_b16 v[140:141], v5 offset:40960
  v_mfma_f32_16x16x32_bf16 v[24:27], v[104:107], v[112:115], v[24:27]
  ds_read_b64_tr_b16 v[142:143], v5 offset:45056
  v_mfma_f32_16x16x32_bf16 v[40:43], v[104:107], v[116:119], v[40:43]
  ds_read_b128 v[156:159], v9 offset:35840
  v_mfma_f32_16x16x32_bf16 v[56:59], v[104:107], v[120:123], v[56:59]
  buffer_load_dwordx2 v[164:165], v15, s[36:39], s60 offen offset:0 sc1
  v_mfma_f32_16x16x32_bf16 v[72:75], v[104:107], v[124:127], v[72:75]
  buffer_load_dwordx2 v[166:167], v15, s[36:39], s60 offen offset:128 sc1
  v_mfma_f32_16x16x32_bf16 v[88:91], v[160:163], v[104:107], v[88:91]
  buffer_load_dwordx2 v[168:169], v15, s[36:39], s60 offen offset:256 sc1
  v_mfma_f32_16x16x32_bf16 v[28:31], v[108:111], v[112:115], v[28:31]
  buffer_load_dwordx2 v[170:171], v15, s[36:39], s60 offen offset:384 sc1
  v_mfma_f32_16x16x32_bf16 v[44:47], v[108:111], v[116:119], v[44:47]
  buffer_load_dword v176, v13, s[36:39], s61 offen sc1
  v_mfma_f32_16x16x32_bf16 v[60:63], v[108:111], v[120:123], v[60:63]
  v_mfma_f32_16x16x32_bf16 v[76:79], v[108:111], v[124:127], v[76:79]
  v_mfma_f32_16x16x32_bf16 v[92:95], v[160:163], v[108:111], v[92:95]
  s_waitcnt lgkmcnt(0)
  s_barrier
  v_mfma_f32_16x16x32_bf16 v[16:19], v[128:131], v[144:147], v[16:19]
  v_xor_b32 v2, 0x10000, v2
  v_xor_b32 v8, 0x10000, v8
  v_mfma_f32_16x16x32_bf16 v[32:35], v[128:131], v[148:151], v[32:35]
  v_xor_b32 v3, 0x10000, v3
  v_xor_b32 v4, 0x10000, v4
  v_mfma_f32_16x16x32_bf16 v[48:51], v[128:131], v[152:155], v[48:51]
  v_xor_b32 v5, 0x10000, v5
  v_xor_b32 v9, 0x10000, v9
  v_mfma_f32_16x16x32_bf16 v[64:67], v[128:131], v[156:159], v[64:67]
  ds_read_b64_tr_b16 v[96:97], v2 offset:0
  v_mfma_f32_16x16x32_bf16 v[80:83], v[160:163], v[128:131], v[80:83]
  ds_read_b64_tr_b16 v[98:99], v2 offset:4096
  v_mfma_f32_16x16x32_bf16 v[20:23], v[132:135], v[144:147], v[20:23]
  ds_read_b128 v[112:115], v8 offset:0
  v_mfma_f32_16x16x32_bf16 v[36:39], v[132:135], v[148:151], v[36:39]
  ds_read_b64_tr_b16 v[100:101], v3 offset:0
  v_mfma_f32_16x16x32_bf16 v[52:55], v[132:135], v[152:155], v[52:55]
  ds_read_b64_tr_b16 v[102:103], v3 offset:4096
  v_mfma_f32_16x16x32_bf16 v[68:71], v[132:135], v[156:159], v[68:71]
  ds_read_b128 v[116:119], v8 offset:1024
  v_mfma_f32_16x16x32_bf16 v[84:87], v[160:163], v[132:135], v[84:87]
  ds_read_b64_tr_b16 v[104:105], v4 offset:0
  v_mfma_f32_16x16x32_bf16 v[24:27], v[136:139], v[144:147], v[24:27]
  ds_read_b64_tr_b16 v[106:107], v4 offset:4096
  v_mfma_f32_16x16x32_bf16 v[40:43], v[136:139], v[148:151], v[40:43]
  ds_read_b128 v[120:123], v8 offset:2048
  v_mfma_f32_16x16x32_bf16 v[56:59], v[136:139], v[152:155], v[56:59]
  ds_read_b64_tr_b16 v[108:109], v5 offset:0
  v_mfma_f32_16x16x32_bf16 v[72:75], v[136:139], v[156:159], v[72:75]
  ds_read_b64_tr_b16 v[110:111], v5 offset:4096
  v_mfma_f32_16x16x32_bf16 v[88:91], v[160:163], v[136:139], v[88:91]
  ds_read_b128 v[124:127], v8 offset:3072
  v_mfma_f32_16x16x32_bf16 v[28:31], v[140:143], v[144:147], v[28:31]
  v_mfma_f32_16x16x32_bf16 v[44:47], v[140:143], v[148:151], v[44:47]
  v_mfma_f32_16x16x32_bf16 v[60:63], v[140:143], v[152:155], v[60:63]
  v_mfma_f32_16x16x32_bf16 v[76:79], v[140:143], v[156:159], v[76:79]
  v_mfma_f32_16x16x32_bf16 v[92:95], v[160:163], v[140:143], v[92:95]
  s_waitcnt lgkmcnt(0)
  v_mfma_f32_16x16x32_bf16 v[16:19], v[96:99], v[112:115], v[16:19]
  ds_read_b64_tr_b16 v[128:129], v2 offset:8192
  v_mfma_f32_16x16x32_bf16 v[32:35], v[96:99], v[116:119], v[32:35]
  ds_read_b64_tr_b16 v[130:131], v2 offset:12288
  v_mfma_f32_16x16x32_bf16 v[48:51], v[96:99], v[120:123], v[48:51]
  ds_read_b128 v[144:147], v9 offset:0
  v_mfma_f32_16x16x32_bf16 v[64:67], v[96:99], v[124:127], v[64:67]
  ds_read_b64_tr_b16 v[132:133], v3 offset:8192
  v_mfma_f32_16x16x32_bf16 v[80:83], v[160:163], v[96:99], v[80:83]
  ds_read_b64_tr_b16 v[134:135], v3 offset:12288
  v_mfma_f32_16x16x32_bf16 v[20:23], v[100:103], v[112:115], v[20:23]
  ds_read_b128 v[148:151], v9 offset:1024
  v_mfma_f32_16x16x32_bf16 v[36:39], v[100:103], v[116:119], v[36:39]
  ds_read_b64_tr_b16 v[136:137], v4 offset:8192
  v_mfma_f32_16x16x32_bf16 v[52:55], v[100:103], v[120:123], v[52:55]
  ds_read_b64_tr_b16 v[138:139], v4 offset:12288
  v_mfma_f32_16x16x32_bf16 v[68:71], v[100:103], v[124:127], v[68:71]
  ds_read_b128 v[152:155], v9 offset:2048
  v_mfma_f32_16x16x32_bf16 v[84:87], v[160:163], v[100:103], v[84:87]
  ds_read_b64_tr_b16 v[140:141], v5 offset:8192
  v_mfma_f32_16x16x32_bf16 v[24:27], v[104:107], v[112:115], v[24:27]
  ds_read_b64_tr_b16 v[142:143], v5 offset:12288
  v_mfma_f32_16x16x32_bf16 v[40:43], v[104:107], v[116:119], v[40:43]
  ds_read_b128 v[156:159], v9 offset:3072
  v_mfma_f32_16x16x32_bf16 v[56:59], v[104:107], v[120:123], v[56:59]
  v_mfma_f32_16x16x32_bf16 v[72:75], v[104:107], v[124:127], v[72:75]
  v_mfma_f32_16x16x32_bf16 v[88:91], v[160:163], v[104:107], v[88:91]
  v_mfma_f32_16x16x32_bf16 v[28:31], v[108:111], v[112:115], v[28:31]
  v_mfma_f32_16x16x32_bf16 v[44:47], v[108:111], v[116:119], v[44:47]
  v_mfma_f32_16x16x32_bf16 v[60:63], v[108:111], v[120:123], v[60:63]
  v_mfma_f32_16x16x32_bf16 v[76:79], v[108:111], v[124:127], v[76:79]
  v_mfma_f32_16x16x32_bf16 v[92:95], v[160:163], v[108:111], v[92:95]
  s_waitcnt lgkmcnt(0)
  s_barrier
  v_mfma_f32_16x16x32_bf16 v[16:19], v[128:131], v[144:147], v[16:19]
  v_xor_b32 v2, 0x10000, v2
  v_xor_b32 v8, 0x10000, v8
  v_mfma_f32_16x16x32_bf16 v[32:35], v[128:131], v[148:151], v[32:35]
  v_xor_b32 v3, 0x10000, v3
  v_xor_b32 v4, 0x10000, v4
  v_mfma_f32_16x16x32_bf16 v[48:51], v[128:131], v[152:155], v[48:51]
  v_xor_b32 v5, 0x10000, v5
  v_xor_b32 v9, 0x10000, v9
  v_mfma_f32_16x16x32_bf16 v[64:67], v[128:131], v[156:159], v[64:67]
  ds_read_b64_tr_b16 v[96:97], v2 offset:0
  v_mfma_f32_16x16x32_bf16 v[80:83], v[160:163], v[128:131], v[80:83]
  ds_read_b64_tr_b16 v[98:99], v2 offset:4096
  v_mfma_f32_16x16x32_bf16 v[20:23], v[132:135], v[144:147], v[20:23]
  ds_read_b128 v[112:115], v8 offset:0
  v_mfma_f32_16x16x32_bf16 v[36:39], v[132:135], v[148:151], v[36:39]
  ds_read_b64_tr_b16 v[100:101], v3 offset:0
  v_mfma_f32_16x16x32_bf16 v[52:55], v[132:135], v[152:155], v[52:55]
  ds_read_b64_tr_b16 v[102:103], v3 offset:4096
  v_mfma_f32_16x16x32_bf16 v[68:71], v[132:135], v[156:159], v[68:71]
  ds_read_b128 v[116:119], v8 offset:1024
  v_mfma_f32_16x16x32_bf16 v[84:87], v[160:163], v[132:135], v[84:87]
  ds_read_b64_tr_b16 v[104:105], v4 offset:0
  v_mfma_f32_16x16x32_bf16 v[24:27], v[136:139], v[144:147], v[24:27]
  ds_read_b64_tr_b16 v[106:107], v4 offset:4096
  v_mfma_f32_16x16x32_bf16 v[40:43], v[136:139], v[148:151], v[40:43]
  ds_read_b128 v[120:123], v8 offset:2048
  v_mfma_f32_16x16x32_bf16 v[56:59], v[136:139], v[152:155], v[56:59]
  ds_read_b64_tr_b16 v[108:109], v5 offset:0
  v_mfma_f32_16x16x32_bf16 v[72:75], v[136:139], v[156:159], v[72:75]
  ds_read_b64_tr_b16 v[110:111], v5 offset:4096
  v_mfma_f32_16x16x32_bf16 v[88:91], v[160:163], v[136:139], v[88:91]
  ds_read_b128 v[124:127], v8 offset:3072
  v_mfma_f32_16x16x32_bf16 v[28:31], v[140:143], v[144:147], v[28:31]
  v_mfma_f32_16x16x32_bf16 v[44:47], v[140:143], v[148:151], v[44:47]
  v_mfma_f32_16x16x32_bf16 v[60:63], v[140:143], v[152:155], v[60:63]
  v_mfma_f32_16x16x32_bf16 v[76:79], v[140:143], v[156:159], v[76:79]
  v_mfma_f32_16x16x32_bf16 v[92:95], v[160:163], v[140:143], v[92:95]
  s_waitcnt lgkmcnt(0)
  v_mfma_f32_16x16x32_bf16 v[16:19], v[96:99], v[112:115], v[16:19]
  ds_read_b64_tr_b16 v[128:129], v2 offset:8192
  v_mfma_f32_16x16x32_bf16 v[32:35], v[96:99], v[116:119], v[32:35]
  ds_read_b64_tr_b16 v[130:131], v2 offset:12288
  v_mfma_f32_16x16x32_bf16 v[48:51], v[96:99], v[120:123], v[48:51]
  ds_read_b128 v[144:147], v9 offset:0
  v_mfma_f32_16x16x32_bf16 v[64:67], v[96:99], v[124:127], v[64:67]
  ds_read_b64_tr_b16 v[132:133], v3 offset:8192
  v_mfma_f32_16x16x32_bf16 v[80:83], v[160:163], v[96:99], v[80:83]
  ds_read_b64_tr_b16 v[134:135], v3 offset:12288
  v_mfma_f32_16x16x32_bf16 v[20:23], v[100:103], v[112:115], v[20:23]
  ds_read_b128 v[148:151], v9 offset:1024
  v_mfma_f32_16x16x32_bf16 v[36:39], v[100:103], v[116:119], v[36:39]
  ds_read_b64_tr_b16 v[136:137], v4 offset:8192
  v_mfma_f32_16x16x32_bf16 v[52:55], v[100:103], v[120:123], v[52:55]
  ds_read_b64_tr_b16 v[138:139], v4 offset:12288
  v_mfma_f32_16x16x32_bf16 v[68:71], v[100:103], v[124:127], v[68:71]
  ds_read_b128 v[152:155], v9 offset:2048
  v_mfma_f32_16x16x32_bf16 v[84:87], v[160:163], v[100:103], v[84:87]
  ds_read_b64_tr_b16 v[140:141], v5 offset:8192
  v_mfma_f32_16x16x32_bf16 v[24:27], v[104:107], v[112:115], v[24:27]
  ds_read_b64_tr_b16 v[142:143], v5 offset:12288
  v_mfma_f32_16x16x32_bf16 v[40:43], v[104:107], v[116:119], v[40:43]
  ds_read_b128 v[156:159], v9 offset:3072
  v_mfma_f32_16x16x32_bf16 v[56:59], v[104:107], v[120:123], v[56:59]
  v_mfma_f32_16x16x32_bf16 v[72:75], v[104:107], v[124:127], v[72:75]
  v_mfma_f32_16x16x32_bf16 v[88:91], v[160:163], v[104:107], v[88:91]
  v_mfma_f32_16x16x32_bf16 v[28:31], v[108:111], v[112:115], v[28:31]
  v_mfma_f32_16x16x32_bf16 v[44:47], v[108:111], v[116:119], v[44:47]
  v_mfma_f32_16x16x32_bf16 v[60:63], v[108:111], v[120:123], v[60:63]
  v_mfma_f32_16x16x32_bf16 v[76:79], v[108:111], v[124:127], v[76:79]
  v_mfma_f32_16x16x32_bf16 v[92:95], v[160:163], v[108:111], v[92:95]
  s_waitcnt lgkmcnt(0)
  v_mfma_f32_16x16x32_bf16 v[16:19], v[128:131], v[144:147], v[16:19]
  v_mfma_f32_16x16x32_bf16 v[32:35], v[128:131], v[148:151], v[32:35]
  v_mfma_f32_16x16x32_bf16 v[48:51], v[128:131], v[152:155], v[48:51]
  v_mfma_f32_16x16x32_bf16 v[64:67], v[128:131], v[156:159], v[64:67]
  v_mfma_f32_16x16x32_bf16 v[80:83], v[160:163], v[128:131], v[80:83]
  v_mfma_f32_16x16x32_bf16 v[20:23], v[132:135], v[144:147], v[20:23]
  v_mfma_f32_16x16x32_bf16 v[36:39], v[132:135], v[148:151], v[36:39]
  v_mfma_f32_16x16x32_bf16 v[52:55], v[132:135], v[152:155], v[52:55]
  v_mfma_f32_16x16x32_bf16 v[68:71], v[132:135], v[156:159], v[68:71]
  v_mfma_f32_16x16x32_bf16 v[84:87], v[160:163], v[132:135], v[84:87]
  v_mfma_f32_16x16x32_bf16 v[24:27], v[136:139], v[144:147], v[24:27]
  v_mfma_f32_16x16x32_bf16 v[40:43], v[136:139], v[148:151], v[40:43]
  v_mfma_f32_16x16x32_bf16 v[56:59], v[136:139], v[152:155], v[56:59]
  v_mfma_f32_16x16x32_bf16 v[72:75], v[136:139], v[156:159], v[72:75]
  v_mfma_f32_16x16x32_bf16 v[88:91], v[160:163], v[136:139], v[88:91]
  v_mfma_f32_16x16x32_bf16 v[28:31], v[140:143], v[144:147], v[28:31]
  v_mfma_f32_16x16x32_bf16 v[44:47], v[140:143], v[148:151], v[44:47]
  v_mfma_f32_16x16x32_bf16 v[60:63], v[140:143], v[152:155], v[60:63]
  v_mfma_f32_16x16x32_bf16 v[76:79], v[140:143], v[156:159], v[76:79]
  v_mfma_f32_16x16x32_bf16 v[92:95], v[160:163], v[140:143], v[92:95]
  s_lshl_b32 s22, s13, 2
  s_add_u32 s22, s22, 163336
  v_mov_b32 v250, s22
  v_mov_b32 v251, 1
  s_mov_b64 exec, 1
  ds_write_b32 v250, v251
  s_mov_b64 exec, -1
  s_branch PF_26
PG_25:
  s_sleep 4
  buffer_load_dwordx2 v[164:165], v15, s[36:39], s60 offen offset:0 sc1
  buffer_load_dwordx2 v[166:167], v15, s[36:39], s60 offen offset:128 sc1
  buffer_load_dwordx2 v[168:169], v15, s[36:39], s60 offen offset:256 sc1
  buffer_load_dwordx2 v[170:171], v15, s[36:39], s60 offen offset:384 sc1
PF_26:
  s_waitcnt vmcnt(0)
  v_cmp_ne_u32 vcc, s100, v165
  v_cmp_ne_u32 s[62:63], s100, v167
  s_nop 2
  s_or_b64 vcc, vcc, s[62:63]
  v_cmp_ne_u32 s[62:63], s100, v169
  s_nop 2
  s_or_b64 vcc, vcc, s[62:63]
  v_cmp_ne_u32 s[62:63], s100, v171
  s_nop 2
  s_or_b64 vcc, vcc, s[62:63]
  s_cbranch_vccz CT_27
  s_add_u32 s79, s79, 1
  s_cmp_lt_u32 s79, 20000
  s_cbranch_scc1 PG_25
CT_27:
  s_getreg_b32 s22, hwreg(HW_REG_XCC_ID, 0, 4)
  s_add_u32 s22, s22, 1
  s_xor_b32 s22, s22, s100
  v_cmp_ne_u32 vcc, s22, v176
  s_nop 2
  s_or_b32 s69, vcc_lo, vcc_hi
  s_lshl_b32 s22, s15, 1
  s_and_b32 s23, s3, 1
  s_add_u32 s22, s22, s23
  s_lshl_b32 s22, s22, 9
  s_mul_i32 s23, s18, 7
  s_add_u32 s23, s23, s45
  s_lshl_b32 s23, s23, 1
  s_add_u32 s23, s23, s19
  s_lshl_b32 s23, s23, 2
  s_add_u32 s22, s22, s23
  s_add_u32 s72, s22, 27312128
  s_cmp_lg_u32 s69, 0
  s_cselect_b32 s73, s72, 0x7f000000
  s_cselect_b32 s72, 0x7f000000, s72
  v_mov_b32 v142, s100
  v_mov_b32 v143, 0
  s_mov_b32 s65, 0xffff0000
  v_lshlrev_b32 v140, 7, v1
  v_cmp_gt_u32 s[70:71], 16, v1
  s_mov_b32 s66, 0x01000100
  v_perm_b32 v104, v164, v164, s66
  v_xor_b32 v104, 0x80008000, v104
  v_lshrrev_b32 v105, 16, v164
  v_perm_b32 v106, v166, v166, s66
  v_xor_b32 v106, 0x80008000, v106
  v_lshrrev_b32 v107, 16, v166
  v_perm_b32 v108, v168, v168, s66
  v_xor_b32 v108, 0x80008000, v108
  v_lshrrev_b32 v109, 16, v168
  v_perm_b32 v110, v170, v170, s66
  v_xor_b32 v110, 0x80008000, v110
  v_lshrrev_b32 v111, 16, v170
  v_cvt_pk_bf16_f32 v81, v80, v80
  v_and_b32 v81, s65, v81
  v_sub_f32 v81, v80, v81
  v_cvt_pk_bf16_f32 v82, v80, v81
  v_cndmask_b32 v96, 0, v82, s[70:71]
  v_cndmask_b32 v97, 0, v172, s[70:71]
  v_cvt_pk_bf16_f32 v85, v84, v84
  v_and_b32 v85, s65, v85
  v_sub_f32 v85, v84, v85
  v_cvt_pk_bf16_f32 v86, v84, v85
  v_cndmask_b32 v98, 0, v86, s[70:71]
  v_cndmask_b32 v99, 0, v173, s[70:71]
  v_cvt_pk_bf16_f32 v89, v88, v88
  v_and_b32 v89, s65, v89
  v_sub_f32 v89, v88, v89
  v_cvt_pk_bf16_f32 v90, v88, v89
  v_cndmask_b32 v100, 0, v90, s[70:71]
  v_cndmask_b32 v101, 0, v174, s[70:71]
  v_cvt_pk_bf16_f32 v93, v92, v92
  v_and_b32 v93, s65, v93
  v_sub_f32 v93, v92, v93
  v_cvt_pk_bf16_f32 v94, v92, v93
  v_cndmask_b32 v102, 0, v94, s[70:71]
  v_cndmask_b32 v103, 0, v175, s[70:71]
  v_mfma_f32_16x16x16_bf16 v[16:19], v[96:97], v[104:105], v[16:19]
  v_mfma_f32_16x16x16_bf16 v[20:23], v[98:99], v[104:105], v[20:23]
  v_mfma_f32_16x16x16_bf16 v[24:27], v[100:101], v[104:105], v[24:27]
  v_mfma_f32_16x16x16_bf16 v[28:31], v[102:103], v[104:105], v[28:31]
  v_and_b32 v146, s65, v164
  v_rcp_f32 v144, v146
  s_nop 0
  v_mul_f32 v145, v144, v144
  v_mul_f32 v145, v145, v144
  v_mul_f32 v145, 0xbdd2d3e8, v145
  v_mul_f32 v144, 0xc0135761, v144
  v_mfma_f32_16x16x16_bf16 v[32:35], v[96:97], v[106:107], v[32:35]
  v_mfma_f32_16x16x16_bf16 v[36:39], v[98:99], v[106:107], v[36:39]
  v_mfma_f32_16x16x16_bf16 v[40:43], v[100:101], v[106:107], v[40:43]
  v_mfma_f32_16x16x16_bf16 v[44:47], v[102:103], v[106:107], v[44:47]
  v_and_b32 v150, s65, v166
  v_rcp_f32 v148, v150
  s_nop 0
  v_mul_f32 v149, v148, v148
  v_mul_f32 v149, v149, v148
  v_mul_f32 v149, 0xbdd2d3e8, v149
  v_mul_f32 v148, 0xc0135761, v148
  v_mfma_f32_16x16x16_bf16 v[48:51], v[96:97], v[108:109], v[48:51]
  v_mfma_f32_16x16x16_bf16 v[52:55], v[98:99], v[108:109], v[52:55]
  v_mfma_f32_16x16x16_bf16 v[56:59], v[100:101], v[108:109], v[56:59]
  v_mfma_f32_16x16x16_bf16 v[60:63], v[102:103], v[108:109], v[60:63]
  v_and_b32 v154, s65, v168
  v_rcp_f32 v152, v154
  s_nop 0
  v_mul_f32 v153, v152, v152
  v_mul_f32 v153, v153, v152
  v_mul_f32 v153, 0xbdd2d3e8, v153
  v_mul_f32 v152, 0xc0135761, v152
  v_mfma_f32_16x16x16_bf16 v[64:67], v[96:97], v[110:111], v[64:67]
  v_mfma_f32_16x16x16_bf16 v[68:71], v[98:99], v[110:111], v[68:71]
  v_mfma_f32_16x16x16_bf16 v[72:75], v[100:101], v[110:111], v[72:75]
  v_mfma_f32_16x16x16_bf16 v[76:79], v[102:103], v[110:111], v[76:79]
  v_and_b32 v158, s65, v170
  v_rcp_f32 v156, v158
  s_nop 0
  v_mul_f32 v157, v156, v156
  v_mul_f32 v157, v157, v156
  v_mul_f32 v157, 0xbdd2d3e8, v157
  v_mul_f32 v156, 0xc0135761, v156
  s_lshl_b32 s66, s15, 3
  s_lshl_b32 s67, s18, 2
  s_add_u32 s66, s66, s67
  s_mul_i32 s66, s66, 55296
  s_lshl_b32 s67, s16, 12
  s_add_u32 s66, s66, s67
  s_lshl_b32 s67, s19, 11
  s_add_u32 s66, s66, s67
  s_cmp_lg_u32 s69, 0
  s_cselect_b32 s67, s66, 0x7f000000
  s_cselect_b32 s66, 0x7f000000, s66
  v_mul_f32 v124, v16, v16
  v_mul_f32 v125, v17, v17
  v_mul_f32 v126, v18, v18
  v_mul_f32 v127, v19, v19
  v_mul_f32 v128, v20, v20
  v_mul_f32 v129, v21, v21
  v_mul_f32 v130, v22, v22
  v_mul_f32 v131, v23, v23
  v_fma_f32 v124, v124, v145, v144
  v_fma_f32 v125, v125, v145, v144
  v_fma_f32 v126, v126, v145, v144
  v_fma_f32 v127, v127, v145, v144
  v_fma_f32 v128, v128, v145, v144
  v_fma_f32 v129, v129, v145, v144
  v_fma_f32 v130, v130, v145, v144
  v_fma_f32 v131, v131, v145, v144
  v_mul_f32 v124, v16, v124
  v_mul_f32 v125, v17, v125
  v_mul_f32 v126, v18, v126
  v_mul_f32 v127, v19, v127
  v_mul_f32 v128, v20, v128
  v_mul_f32 v129, v21, v129
  v_mul_f32 v130, v22, v130
  v_mul_f32 v131, v23, v131
  v_exp_f32 v124, v124
  v_exp_f32 v125, v125
  v_exp_f32 v126, v126
  v_exp_f32 v127, v127
  v_exp_f32 v128, v128
  v_exp_f32 v129, v129
  v_exp_f32 v130, v130
  v_exp_f32 v131, v131
  v_fma_f32 v124, v124, v146, v146
  v_fma_f32 v125, v125, v146, v146
  v_fma_f32 v126, v126, v146, v146
  v_fma_f32 v127, v127, v146, v146
  v_fma_f32 v128, v128, v146, v146
  v_fma_f32 v129, v129, v146, v146
  v_fma_f32 v130, v130, v146, v146
  v_fma_f32 v131, v131, v146, v146
  v_rcp_f32 v124, v124
  v_rcp_f32 v125, v125
  v_rcp_f32 v126, v126
  v_rcp_f32 v127, v127
  v_rcp_f32 v128, v128
  v_rcp_f32 v129, v129
  v_rcp_f32 v130, v130
  v_rcp_f32 v131, v131
  v_mul_f32 v16, v16, v124
  v_mul_f32 v17, v17, v125
  v_mul_f32 v18, v18, v126
  v_mul_f32 v19, v19, v127
  v_mul_f32 v20, v20, v128
  v_mul_f32 v21, v21, v129
  v_mul_f32 v22, v22, v130
  v_mul_f32 v23, v23, v131
  v_cvt_pk_bf16_f32 v132, v16, v17
  v_cvt_pk_bf16_f32 v133, v18, v19
  v_cvt_pk_bf16_f32 v134, v20, v21
  v_cvt_pk_bf16_f32 v135, v22, v23
  buffer_store_dwordx4 v[132:135], v14, s[36:39], s66 offen offset:0
  buffer_store_dwordx4 v[132:135], v14, s[36:39], s67 offen offset:0 sc1
  v_mul_f32 v124, v24, v24
  v_mul_f32 v125, v25, v25
  v_mul_f32 v126, v26, v26
  v_mul_f32 v127, v27, v27
  v_mul_f32 v128, v28, v28
  v_mul_f32 v129, v29, v29
  v_mul_f32 v130, v30, v30
  v_mul_f32 v131, v31, v31
  v_fma_f32 v124, v124, v145, v144
  v_fma_f32 v125, v125, v145, v144
  v_fma_f32 v126, v126, v145, v144
  v_fma_f32 v127, v127, v145, v144
  v_fma_f32 v128, v128, v145, v144
  v_fma_f32 v129, v129, v145, v144
  v_fma_f32 v130, v130, v145, v144
  v_fma_f32 v131, v131, v145, v144
  v_mul_f32 v124, v24, v124
  v_mul_f32 v125, v25, v125
  v_mul_f32 v126, v26, v126
  v_mul_f32 v127, v27, v127
  v_mul_f32 v128, v28, v128
  v_mul_f32 v129, v29, v129
  v_mul_f32 v130, v30, v130
  v_mul_f32 v131, v31, v131
  v_exp_f32 v124, v124
  v_exp_f32 v125, v125
  v_exp_f32 v126, v126
  v_exp_f32 v127, v127
  v_exp_f32 v128, v128
  v_exp_f32 v129, v129
  v_exp_f32 v130, v130
  v_exp_f32 v131, v131
  v_fma_f32 v124, v124, v146, v146
  v_fma_f32 v125, v125, v146, v146
  v_fma_f32 v126, v126, v146, v146
  v_fma_f32 v127, v127, v146, v146
  v_fma_f32 v128, v128, v146, v146
  v_fma_f32 v129, v129, v146, v146
  v_fma_f32 v130, v130, v146, v146
  v_fma_f32 v131, v131, v146, v146
  v_rcp_f32 v124, v124
  v_rcp_f32 v125, v125
  v_rcp_f32 v126, v126
  v_rcp_f32 v127, v127
  v_rcp_f32 v128, v128
  v_rcp_f32 v129, v129
  v_rcp_f32 v130, v130
  v_rcp_f32 v131, v131
  v_mul_f32 v24, v24, v124
  v_mul_f32 v25, v25, v125
  v_mul_f32 v26, v26, v126
  v_mul_f32 v27, v27, v127
  v_mul_f32 v28, v28, v128
  v_mul_f32 v29, v29, v129
  v_mul_f32 v30, v30, v130
  v_mul_f32 v31, v31, v131
  v_cvt_pk_bf16_f32 v136, v24, v25
  v_cvt_pk_bf16_f32 v137, v26, v27
  v_cvt_pk_bf16_f32 v138, v28, v29
  v_cvt_pk_bf16_f32 v139, v30, v31
  buffer_store_dwordx4 v[136:139], v14, s[36:39], s66 offen offset:1024
  buffer_store_dwordx4 v[136:139], v14, s[36:39], s67 offen offset:1024 sc1
  s_add_u32 s66, s66, 55296
  s_add_u32 s67, s67, 55296
  v_mul_f32 v124, v32, v32
  v_mul_f32 v125, v33, v33
  v_mul_f32 v126, v34, v34
  v_mul_f32 v127, v35, v35
  v_mul_f32 v128, v36, v36
  v_mul_f32 v129, v37, v37
  v_mul_f32 v130, v38, v38
  v_mul_f32 v131, v39, v39
  v_fma_f32 v124, v124, v149, v148
  v_fma_f32 v125, v125, v149, v148
  v_fma_f32 v126, v126, v149, v148
  v_fma_f32 v127, v127, v149, v148
  v_fma_f32 v128, v128, v149, v148
  v_fma_f32 v129, v129, v149, v148
  v_fma_f32 v130, v130, v149, v148
  v_fma_f32 v131, v131, v149, v148
  v_mul_f32 v124, v32, v124
  v_mul_f32 v125, v33, v125
  v_mul_f32 v126, v34, v126
  v_mul_f32 v127, v35, v127
  v_mul_f32 v128, v36, v128
  v_mul_f32 v129, v37, v129
  v_mul_f32 v130, v38, v130
  v_mul_f32 v131, v39, v131
  v_exp_f32 v124, v124
  v_exp_f32 v125, v125
  v_exp_f32 v126, v126
  v_exp_f32 v127, v127
  v_exp_f32 v128, v128
  v_exp_f32 v129, v129
  v_exp_f32 v130, v130
  v_exp_f32 v131, v131
  v_fma_f32 v124, v124, v150, v150
  v_fma_f32 v125, v125, v150, v150
  v_fma_f32 v126, v126, v150, v150
  v_fma_f32 v127, v127, v150, v150
  v_fma_f32 v128, v128, v150, v150
  v_fma_f32 v129, v129, v150, v150
  v_fma_f32 v130, v130, v150, v150
  v_fma_f32 v131, v131, v150, v150
  v_rcp_f32 v124, v124
  v_rcp_f32 v125, v125
  v_rcp_f32 v126, v126
  v_rcp_f32 v127, v127
  v_rcp_f32 v128, v128
  v_rcp_f32 v129, v129
  v_rcp_f32 v130, v130
  v_rcp_f32 v131, v131
  v_mul_f32 v32, v32, v124
  v_mul_f32 v33, v33, v125
  v_mul_f32 v34, v34, v126
  v_mul_f32 v35, v35, v127
  v_mul_f32 v36, v36, v128
  v_mul_f32 v37, v37, v129
  v_mul_f32 v38, v38, v130
  v_mul_f32 v39, v39, v131
  v_cvt_pk_bf16_f32 v132, v32, v33
  v_cvt_pk_bf16_f32 v133, v34, v35
  v_cvt_pk_bf16_f32 v134, v36, v37
  v_cvt_pk_bf16_f32 v135, v38, v39
  buffer_store_dwordx4 v[132:135], v14, s[36:39], s66 offen offset:0
  buffer_store_dwordx4 v[132:135], v14, s[36:39], s67 offen offset:0 sc1
  v_mul_f32 v124, v40, v40
  v_mul_f32 v125, v41, v41
  v_mul_f32 v126, v42, v42
  v_mul_f32 v127, v43, v43
  v_mul_f32 v128, v44, v44
  v_mul_f32 v129, v45, v45
  v_mul_f32 v130, v46, v46
  v_mul_f32 v131, v47, v47
  v_fma_f32 v124, v124, v149, v148
  v_fma_f32 v125, v125, v149, v148
  v_fma_f32 v126, v126, v149, v148
  v_fma_f32 v127, v127, v149, v148
  v_fma_f32 v128, v128, v149, v148
  v_fma_f32 v129, v129, v149, v148
  v_fma_f32 v130, v130, v149, v148
  v_fma_f32 v131, v131, v149, v148
  v_mul_f32 v124, v40, v124
  v_mul_f32 v125, v41, v125
  v_mul_f32 v126, v42, v126
  v_mul_f32 v127, v43, v127
  v_mul_f32 v128, v44, v128
  v_mul_f32 v129, v45, v129
  v_mul_f32 v130, v46, v130
  v_mul_f32 v131, v47, v131
  v_exp_f32 v124, v124
  v_exp_f32 v125, v125
  v_exp_f32 v126, v126
  v_exp_f32 v127, v127
  v_exp_f32 v128, v128
  v_exp_f32 v129, v129
  v_exp_f32 v130, v130
  v_exp_f32 v131, v131
  v_fma_f32 v124, v124, v150, v150
  v_fma_f32 v125, v125, v150, v150
  v_fma_f32 v126, v126, v150, v150
  v_fma_f32 v127, v127, v150, v150
  v_fma_f32 v128, v128, v150, v150
  v_fma_f32 v129, v129, v150, v150
  v_fma_f32 v130, v130, v150, v150
  v_fma_f32 v131, v131, v150, v150
  v_rcp_f32 v124, v124
  v_rcp_f32 v125, v125
  v_rcp_f32 v126, v126
  v_rcp_f32 v127, v127
  v_rcp_f32 v128, v128
  v_rcp_f32 v129, v129
  v_rcp_f32 v130, v130
  v_rcp_f32 v131, v131
  v_mul_f32 v40, v40, v124
  v_mul_f32 v41, v41, v125
  v_mul_f32 v42, v42, v126
  v_mul_f32 v43, v43, v127
  v_mul_f32 v44, v44, v128
  v_mul_f32 v45, v45, v129
  v_mul_f32 v46, v46, v130
  v_mul_f32 v47, v47, v131
  v_cvt_pk_bf16_f32 v136, v40, v41
  v_cvt_pk_bf16_f32 v137, v42, v43
  v_cvt_pk_bf16_f32 v138, v44, v45
  v_cvt_pk_bf16_f32 v139, v46, v47
  s_mov_b64 exec, 1
  s_waitcnt vmcnt(2)
  buffer_store_dword v142, v143, s[36:39], s72 offen offset:0
  buffer_store_dword v142, v143, s[36:39], s73 offen offset:0 sc1
  s_mov_b64 exec, -1
  buffer_store_dwordx4 v[136:139], v14, s[36:39], s66 offen offset:1024
  buffer_store_dwordx4 v[136:139], v14, s[36:39], s67 offen offset:1024 sc1
  s_add_u32 s66, s66, 55296
  s_add_u32 s67, s67, 55296
  s_lshl_b32 s22, s13, 2
  s_add_u32 s22, s22, 163336
  v_mov_b32 v250, s22
  v_mov_b32 v251, 2
  s_mov_b64 exec, 1
  ds_write_b32 v250, v251
  s_mov_b64 exec, -1
  v_mul_f32 v124, v48, v48
  v_mul_f32 v125, v49, v49
  v_mul_f32 v126, v50, v50
  v_mul_f32 v127, v51, v51
  v_mul_f32 v128, v52, v52
  v_mul_f32 v129, v53, v53
  v_mul_f32 v130, v54, v54
  v_mul_f32 v131, v55, v55
  v_fma_f32 v124, v124, v153, v152
  v_fma_f32 v125, v125, v153, v152
  v_fma_f32 v126, v126, v153, v152
  v_fma_f32 v127, v127, v153, v152
  v_fma_f32 v128, v128, v153, v152
  v_fma_f32 v129, v129, v153, v152
  v_fma_f32 v130, v130, v153, v152
  v_fma_f32 v131, v131, v153, v152
  v_mul_f32 v124, v48, v124
  v_mul_f32 v125, v49, v125
  v_mul_f32 v126, v50, v126
  v_mul_f32 v127, v51, v127
  v_mul_f32 v128, v52, v128
  v_mul_f32 v129, v53, v129
  v_mul_f32 v130, v54, v130
  v_mul_f32 v131, v55, v131
  v_exp_f32 v124, v124
  v_exp_f32 v125, v125
  v_exp_f32 v126, v126
  v_exp_f32 v127, v127
  v_exp_f32 v128, v128
  v_exp_f32 v129, v129
  v_exp_f32 v130, v130
  v_exp_f32 v131, v131
  v_fma_f32 v124, v124, v154, v154
  v_fma_f32 v125, v125, v154, v154
  v_fma_f32 v126, v126, v154, v154
  v_fma_f32 v127, v127, v154, v154
  v_fma_f32 v128, v128, v154, v154
  v_fma_f32 v129, v129, v154, v154
  v_fma_f32 v130, v130, v154, v154
  v_fma_f32 v131, v131, v154, v154
  v_rcp_f32 v124, v124
  v_rcp_f32 v125, v125
  v_rcp_f32 v126, v126
  v_rcp_f32 v127, v127
  v_rcp_f32 v128, v128
  v_rcp_f32 v129, v129
  v_rcp_f32 v130, v130
  v_rcp_f32 v131, v131
  v_mul_f32 v48, v48, v124
  v_mul_f32 v49, v49, v125
  v_mul_f32 v50, v50, v126
  v_mul_f32 v51, v51, v127
  v_mul_f32 v52, v52, v128
  v_mul_f32 v53, v53, v129
  v_mul_f32 v54, v54, v130
  v_mul_f32 v55, v55, v131
  v_cvt_pk_bf16_f32 v132, v48, v49
  v_cvt_pk_bf16_f32 v133, v50, v51
  v_cvt_pk_bf16_f32 v134, v52, v53
  v_cvt_pk_bf16_f32 v135, v54, v55
  buffer_store_dwordx4 v[132:135], v14, s[36:39], s66 offen offset:0
  buffer_store_dwordx4 v[132:135], v14, s[36:39], s67 offen offset:0 sc1
  v_mul_f32 v124, v56, v56
  v_mul_f32 v125, v57, v57
  v_mul_f32 v126, v58, v58
  v_mul_f32 v127, v59, v59
  v_mul_f32 v128, v60, v60
  v_mul_f32 v129, v61, v61
  v_mul_f32 v130, v62, v62
  v_mul_f32 v131, v63, v63
  v_fma_f32 v124, v124, v153, v152
  v_fma_f32 v125, v125, v153, v152
  v_fma_f32 v126, v126, v153, v152
  v_fma_f32 v127, v127, v153, v152
  v_fma_f32 v128, v128, v153, v152
  v_fma_f32 v129, v129, v153, v152
  v_fma_f32 v130, v130, v153, v152
  v_fma_f32 v131, v131, v153, v152
  v_mul_f32 v124, v56, v124
  v_mul_f32 v125, v57, v125
  v_mul_f32 v126, v58, v126
  v_mul_f32 v127, v59, v127
  v_mul_f32 v128, v60, v128
  v_mul_f32 v129, v61, v129
  v_mul_f32 v130, v62, v130
  v_mul_f32 v131, v63, v131
  v_exp_f32 v124, v124
  v_exp_f32 v125, v125
  v_exp_f32 v126, v126
  v_exp_f32 v127, v127
  v_exp_f32 v128, v128
  v_exp_f32 v129, v129
  v_exp_f32 v130, v130
  v_exp_f32 v131, v131
  v_fma_f32 v124, v124, v154, v154
  v_fma_f32 v125, v125, v154, v154
  v_fma_f32 v126, v126, v154, v154
  v_fma_f32 v127, v127, v154, v154
  v_fma_f32 v128, v128, v154, v154
  v_fma_f32 v129, v129, v154, v154
  v_fma_f32 v130, v130, v154, v154
  v_fma_f32 v131, v131, v154, v154
  v_rcp_f32 v124, v124
  v_rcp_f32 v125, v125
  v_rcp_f32 v126, v126
  v_rcp_f32 v127, v127
  v_rcp_f32 v128, v128
  v_rcp_f32 v129, v129
  v_rcp_f32 v130, v130
  v_rcp_f32 v131, v131
  v_mul_f32 v56, v56, v124
  v_mul_f32 v57, v57, v125
  v_mul_f32 v58, v58, v126
  v_mul_f32 v59, v59, v127
  v_mul_f32 v60, v60, v128
  v_mul_f32 v61, v61, v129
  v_mul_f32 v62, v62, v130
  v_mul_f32 v63, v63, v131
  v_cvt_pk_bf16_f32 v136, v56, v57
  v_cvt_pk_bf16_f32 v137, v58, v59
  v_cvt_pk_bf16_f32 v138, v60, v61
  v_cvt_pk_bf16_f32 v139, v62, v63
  s_mov_b64 exec, 1
  s_waitcnt vmcnt(2)
  buffer_store_dword v142, v143, s[36:39], s72 offen offset:128
  buffer_store_dword v142, v143, s[36:39], s73 offen offset:128 sc1
  s_mov_b64 exec, -1
  buffer_store_dwordx4 v[136:139], v14, s[36:39], s66 offen offset:1024
  buffer_store_dwordx4 v[136:139], v14, s[36:39], s67 offen offset:1024 sc1
  s_add_u32 s66, s66, 55296
  s_add_u32 s67, s67, 55296
  v_mul_f32 v124, v64, v64
  v_mul_f32 v125, v65, v65
  v_mul_f32 v126, v66, v66
  v_mul_f32 v127, v67, v67
  v_mul_f32 v128, v68, v68
  v_mul_f32 v129, v69, v69
  v_mul_f32 v130, v70, v70
  v_mul_f32 v131, v71, v71
  v_fma_f32 v124, v124, v157, v156
  v_fma_f32 v125, v125, v157, v156
  v_fma_f32 v126, v126, v157, v156
  v_fma_f32 v127, v127, v157, v156
  v_fma_f32 v128, v128, v157, v156
  v_fma_f32 v129, v129, v157, v156
  v_fma_f32 v130, v130, v157, v156
  v_fma_f32 v131, v131, v157, v156
  v_mul_f32 v124, v64, v124
  v_mul_f32 v125, v65, v125
  v_mul_f32 v126, v66, v126
  v_mul_f32 v127, v67, v127
  v_mul_f32 v128, v68, v128
  v_mul_f32 v129, v69, v129
  v_mul_f32 v130, v70, v130
  v_mul_f32 v131, v71, v131
  v_exp_f32 v124, v124
  v_exp_f32 v125, v125
  v_exp_f32 v126, v126
  v_exp_f32 v127, v127
  v_exp_f32 v128, v128
  v_exp_f32 v129, v129
  v_exp_f32 v130, v130
  v_exp_f32 v131, v131
  v_fma_f32 v124, v124, v158, v158
  v_fma_f32 v125, v125, v158, v158
  v_fma_f32 v126, v126, v158, v158
  v_fma_f32 v127, v127, v158, v158
  v_fma_f32 v128, v128, v158, v158
  v_fma_f32 v129, v129, v158, v158
  v_fma_f32 v130, v130, v158, v158
  v_fma_f32 v131, v131, v158, v158
  v_rcp_f32 v124, v124
  v_rcp_f32 v125, v125
  v_rcp_f32 v126, v126
  v_rcp_f32 v127, v127
  v_rcp_f32 v128, v128
  v_rcp_f32 v129, v129
  v_rcp_f32 v130, v130
  v_rcp_f32 v131, v131
  v_mul_f32 v64, v64, v124
  v_mul_f32 v65, v65, v125
  v_mul_f32 v66, v66, v126
  v_mul_f32 v67, v67, v127
  v_mul_f32 v68, v68, v128
  v_mul_f32 v69, v69, v129
  v_mul_f32 v70, v70, v130
  v_mul_f32 v71, v71, v131
  v_cvt_pk_bf16_f32 v132, v64, v65
  v_cvt_pk_bf16_f32 v133, v66, v67
  v_cvt_pk_bf16_f32 v134, v68, v69
  v_cvt_pk_bf16_f32 v135, v70, v71
  buffer_store_dwordx4 v[132:135], v14, s[36:39], s66 offen offset:0
  buffer_store_dwordx4 v[132:135], v14, s[36:39], s67 offen offset:0 sc1
  v_mul_f32 v124, v72, v72
  v_mul_f32 v125, v73, v73
  v_mul_f32 v126, v74, v74
  v_mul_f32 v127, v75, v75
  v_mul_f32 v128, v76, v76
  v_mul_f32 v129, v77, v77
  v_mul_f32 v130, v78, v78
  v_mul_f32 v131, v79, v79
  v_fma_f32 v124, v124, v157, v156
  v_fma_f32 v125, v125, v157, v156
  v_fma_f32 v126, v126, v157, v156
  v_fma_f32 v127, v127, v157, v156
  v_fma_f32 v128, v128, v157, v156
  v_fma_f32 v129, v129, v157, v156
  v_fma_f32 v130, v130, v157, v156
  v_fma_f32 v131, v131, v157, v156
  v_mul_f32 v124, v72, v124
  v_mul_f32 v125, v73, v125
  v_mul_f32 v126, v74, v126
  v_mul_f32 v127, v75, v127
  v_mul_f32 v128, v76, v128
  v_mul_f32 v129, v77, v129
  v_mul_f32 v130, v78, v130
  v_mul_f32 v131, v79, v131
  v_exp_f32 v124, v124
  v_exp_f32 v125, v125
  v_exp_f32 v126, v126
  v_exp_f32 v127, v127
  v_exp_f32 v128, v128
  v_exp_f32 v129, v129
  v_exp_f32 v130, v130
  v_exp_f32 v131, v131
  v_fma_f32 v124, v124, v158, v158
  v_fma_f32 v125, v125, v158, v158
  v_fma_f32 v126, v126, v158, v158
  v_fma_f32 v127, v127, v158, v158
  v_fma_f32 v128, v128, v158, v158
  v_fma_f32 v129, v129, v158, v158
  v_fma_f32 v130, v130, v158, v158
  v_fma_f32 v131, v131, v158, v158
  v_rcp_f32 v124, v124
  v_rcp_f32 v125, v125
  v_rcp_f32 v126, v126
  v_rcp_f32 v127, v127
  v_rcp_f32 v128, v128
  v_rcp_f32 v129, v129
  v_rcp_f32 v130, v130
  v_rcp_f32 v131, v131
  v_mul_f32 v72, v72, v124
  v_mul_f32 v73, v73, v125
  v_mul_f32 v74, v74, v126
  v_mul_f32 v75, v75, v127
  v_mul_f32 v76, v76, v128
  v_mul_f32 v77, v77, v129
  v_mul_f32 v78, v78, v130
  v_mul_f32 v79, v79, v131
  v_cvt_pk_bf16_f32 v136, v72, v73
  v_cvt_pk_bf16_f32 v137, v74, v75
  v_cvt_pk_bf16_f32 v138, v76, v77
  v_cvt_pk_bf16_f32 v139, v78, v79
  s_mov_b64 exec, 1
  s_waitcnt vmcnt(2)
  buffer_store_dword v142, v143, s[36:39], s72 offen offset:256
  buffer_store_dword v142, v143, s[36:39], s73 offen offset:256 sc1
  s_mov_b64 exec, -1
  buffer_store_dwordx4 v[136:139], v14, s[36:39], s66 offen offset:1024
  buffer_store_dwordx4 v[136:139], v14, s[36:39], s67 offen offset:1024 sc1
  s_mov_b64 exec, 1
  s_waitcnt vmcnt(0)
  buffer_store_dword v142, v143, s[36:39], s72 offen offset:384
  buffer_store_dword v142, v143, s[36:39], s73 offen offset:384 sc1
  s_mov_b64 exec, -1
G2:
  s_load_dwordx4 s[8:11], s[0:1], 104
  s_load_dwordx2 s[4:5], s[0:1], 0
  v_min_u32 v200, 27, v1
  s_and_b32 s22, s3, 1
  v_subrev_u32 v201, s22, v200
  v_cmp_eq_u32 vcc, 13, v200
  v_cmp_eq_u32 s[62:63], 27, v200
  s_nop 2
  s_or_b64 vcc, vcc, s[62:63]
  v_cndmask_b32 v200, v200, v201, vcc
  v_lshlrev_b32 v200, 2, v200
  s_lshl_b32 s59, s15, 1
  s_add_u32 s59, s59, s22
  s_lshl_b32 s59, s59, 2
  s_add_u32 s59, s59, s13
  s_lshl_b32 s59, s59, 7
  s_add_u32 s59, s59, 27312128
  buffer_load_dword v15, v200, s[36:39], s59 offen sc1
  s_and_b32 s46, s14, 3
  s_mul_i32 s46, s46, 7
  s_lshr_b32 s22, s3, 1
  s_mul_i32 s22, s22, 2
  s_add_u32 s46, s46, s22
  s_lshr_b32 s22, s14, 2
  s_mul_i32 s22, s22, 7
  s_lshr_b32 s22, s22, 1
  s_add_u32 s46, s46, s22
  s_and_b32 s78, s3, 1
  s_lshl_b32 s64, s78, 1
  s_sub_u32 s64, 28, s64
  s_sub_u32 s22, s46, s64
  s_cmp_ge_u32 s46, s64
  s_cselect_b32 s46, s22, s46
  s_sub_u32 s22, s46, s64
  s_cmp_ge_u32 s46, s64
  s_cselect_b32 s46, s22, s46
  v_lshlrev_b32 v2, 4, v1
  v_lshlrev_b32 v10, 3, v1
  v_lshrrev_b32 v9, 2, v1
  v_mul_u32_u24 v9, 160, v9
  v_and_b32 v3, 3, v1
  v_lshl_add_u32 v9, v3, 3, v9
  v_add_u32 v3, 142848, v9
  v_add_u32 v4, 32768, v9
  s_lshl_b32 s57, s15, 1
  s_add_u32 s57, s57, s78
  s_lshl_b32 s57, s57, 2
  s_add_u32 s57, s57, s13
  s_xor_b32 s22, s57, 4
  s_mul_i32 s22, s22, 55296
  v_add_u32 v7, s22, v2
  s_mul_i32 s22, s57, 55296
  v_add_u32 v8, s22, v2
  s_mul_i32 s56, s78, 28672
  s_lshl_b32 s72, s46, 10
  s_add_u32 s72, s72, s56
  s_lshl_b32 s71, s64, 10
  s_add_u32 s71, s71, s56
  v_add_u32 v11, 0, v1
  v_mul_u32_u24 v12, 6554, v11
  v_lshrrev_b32 v12, 16, v12
  v_mul_u32_u24 v240, 1120, v12
  v_lshl_add_u32 v240, v11, 4, v240
  v_add_u32 v11, 64, v1
  v_mul_u32_u24 v12, 6554, v11
  v_lshrrev_b32 v12, 16, v12
  v_mul_u32_u24 v241, 1120, v12
  v_lshl_add_u32 v241, v11, 4, v241
  v_add_u32 v11, 128, v1
  v_mul_u32_u24 v12, 6554, v11
  v_lshrrev_b32 v12, 16, v12
  v_mul_u32_u24 v242, 1120, v12
  v_lshl_add_u32 v242, v11, 4, v242
  s_mul_i32 s58, s57, 20480
  s_mul_i32 s22, s45, 160
  s_add_u32 s58, s58, s22
  v_mov_b32 v254, 0
  s_lshl_b32 s73, s45, 7
  s_add_u32 s73, s73, 27271168
  v_lshrrev_b32 v11, 3, v1
  v_lshlrev_b32 v11, 12, v11
  v_and_b32 v12, 7, v1
  v_lshl_add_u32 v11, v12, 4, v11
  s_lshl_b32 s61, s45, 2
  s_add_u32 s61, s61, s13
  s_mul_i32 s61, s61, 81920
  s_lshr_b32 s23, s57, 2
  s_lshl_b32 s23, s23, 7
  s_add_u32 s61, s61, s23
  s_add_u32 s61, s61, 20971520
  v_lshrrev_b32 v12, 4, v1
  v_lshlrev_b32 v14, 3, v12
  s_mul_i32 s60, s13, 5120
  s_add_u32 s60, s60, 43008
  v_add_u32 v253, s60, v2
  v_mov_b32 v5, 163328
  v_and_b32 v13, 15, v1
  v_mul_u32_u24 v13, 160, v13
  v_add3_u32 v13, v13, v14, s60
  v_and_b32 v248, 3, v1
  v_lshlrev_b32 v248, 3, v248
  s_lshl_b32 s22, s13, 5
  s_add_u32 s22, s22, 45568
  v_add_u32 v248, s22, v248
  v_lshrrev_b32 v249, 2, v1
  v_add_u32 v249, 0, v249
  v_mul_u32_u24 v252, 3277, v249
  v_lshrrev_b32 v252, 16, v252
  v_mul_u32_u24 v252, 2560, v252
  v_lshl_add_u32 v252, v249, 7, v252
  v_add_u32 v243, v252, v248
  v_lshrrev_b32 v249, 2, v1
  v_add_u32 v249, 16, v249
  v_mul_u32_u24 v252, 3277, v249
  v_lshrrev_b32 v252, 16, v252
  v_mul_u32_u24 v252, 2560, v252
  v_lshl_add_u32 v252, v249, 7, v252
  v_add_u32 v244, v252, v248
  v_lshrrev_b32 v249, 2, v1
  v_add_u32 v249, 32, v249
  v_mul_u32_u24 v252, 3277, v249
  v_lshrrev_b32 v252, 16, v252
  v_mul_u32_u24 v252, 2560, v252
  v_lshl_add_u32 v252, v249, 7, v252
  v_add_u32 v245, v252, v248
  v_lshrrev_b32 v249, 2, v1
  v_add_u32 v249, 48, v249
  v_mul_u32_u24 v252, 3277, v249
  v_lshrrev_b32 v252, 16, v252
  v_mul_u32_u24 v252, 2560, v252
  v_lshl_add_u32 v252, v249, 7, v252
  v_add_u32 v246, v252, v248
  v_lshrrev_b32 v249, 2, v1
  v_add_u32 v249, 64, v249
  v_mul_u32_u24 v252, 3277, v249
  v_lshrrev_b32 v252, 16, v252
  v_mul_u32_u24 v252, 2560, v252
  v_lshl_add_u32 v252, v249, 7, v252
  v_add_u32 v247, v252, v248
  v_and_b32 v12, 3, v1
  v_lshlrev_b32 v12, 2, v12
  v_add_u32 v12, 163336, v12
  s_lshl_b32 s66, s2, 2
  s_add_u32 s66, s66, s13
  s_xor_b32 s67, s66, 4
  s_lshl_b32 s68, s66, 7
  s_add_u32 s68, s68, 27328512
  s_lshl_b32 s69, s67, 7
  s_add_u32 s69, s69, 27328512
  s_lshl_b32 s66, s66, 12
  s_add_u32 s66, s66, 16777216
  s_lshl_b32 s67, s67, 12
  s_add_u32 s67, s67, 16777216
  s_waitcnt lgkmcnt(0)
  s_mov_b32 s48, s10
  s_and_b32 s49, s11, 0xffff
  s_mov_b32 s50, 2621440
  s_mov_b32 s51, 0x20000
  s_mov_b32 s52, s8
  s_and_b32 s53, s9, 0xffff
  s_mov_b32 s54, 1280
  s_mov_b32 s55, 0x20000
  s_mov_b32 s24, s4
  s_and_b32 s25, s5, 0xffff
  s_mov_b32 s26, 2621440
  s_mov_b32 s27, 0x20000
SG_28:
  ds_read_b32 v6, v5
  s_waitcnt lgkmcnt(0)
  v_cmp_gt_u32 vcc, 10, v6
  s_cbranch_vccz SO_29
  s_sleep 1
  s_add_u32 s79, s79, 1
  s_cmp_lt_u32 s79, 200000
  s_cbranch_scc1 SG_28
SO_29:
  ds_read_b64_tr_b16 v[56:57], v3 offset:0
  ds_read_b64_tr_b16 v[58:59], v3 offset:2560
  ds_read_b64_tr_b16 v[60:61], v3 offset:32
  ds_read_b64_tr_b16 v[62:63], v3 offset:2592
  ds_read_b64_tr_b16 v[64:65], v3 offset:64
  ds_read_b64_tr_b16 v[66:67], v3 offset:2624
  ds_read_b64_tr_b16 v[68:69], v3 offset:96
  ds_read_b64_tr_b16 v[70:71], v3 offset:2656
  ds_read_b64_tr_b16 v[72:73], v3 offset:128
  ds_read_b64_tr_b16 v[74:75], v3 offset:2688
  ds_read_b64_tr_b16 v[76:77], v3 offset:5120
  ds_read_b64_tr_b16 v[78:79], v3 offset:7680
  ds_read_b64_tr_b16 v[80:81], v3 offset:5152
  ds_read_b64_tr_b16 v[82:83], v3 offset:7712
  ds_read_b64_tr_b16 v[84:85], v3 offset:5184
  ds_read_b64_tr_b16 v[86:87], v3 offset:7744
  ds_read_b64_tr_b16 v[88:89], v3 offset:5216
  ds_read_b64_tr_b16 v[90:91], v3 offset:7776
  ds_read_b64_tr_b16 v[92:93], v3 offset:5248
  ds_read_b64_tr_b16 v[94:95], v3 offset:7808
  s_branch PF_31
PG_30:
  s_sleep 1
  buffer_load_dword v15, v200, s[36:39], s59 offen sc1
PF_31:
  s_waitcnt vmcnt(0)
  v_cmp_ne_u32 vcc, s100, v15
  s_cbranch_vccz CT_32
  s_add_u32 s79, s79, 1
  s_cmp_lt_u32 s79, 20000
  s_cbranch_scc1 PG_30
CT_32:
  buffer_load_dwordx4 v[96:99], v7, s[36:39], s72 offen sc1
  buffer_load_dwordx4 v[100:103], v8, s[36:39], s72 offen sc1
  s_add_u32 s72, s72, 1024
  s_cmp_eq_u32 s72, s71
  s_cselect_b32 s72, s56, s72
  buffer_load_dwordx4 v[104:107], v7, s[36:39], s72 offen sc1
  buffer_load_dwordx4 v[108:111], v8, s[36:39], s72 offen sc1
  s_add_u32 s72, s72, 1024
  s_cmp_eq_u32 s72, s71
  s_cselect_b32 s72, s56, s72
  buffer_load_dwordx4 v[112:115], v7, s[36:39], s72 offen sc1
  buffer_load_dwordx4 v[116:119], v8, s[36:39], s72 offen sc1
  s_add_u32 s72, s72, 1024
  s_cmp_eq_u32 s72, s71
  s_cselect_b32 s72, s56, s72
  buffer_load_dwordx4 v[120:123], v7, s[36:39], s72 offen sc1
  buffer_load_dwordx4 v[124:127], v8, s[36:39], s72 offen sc1
  s_add_u32 s72, s72, 1024
  s_cmp_eq_u32 s72, s71
  s_cselect_b32 s72, s56, s72
  buffer_load_dwordx4 v[128:131], v7, s[36:39], s72 offen sc1
  buffer_load_dwordx4 v[132:135], v8, s[36:39], s72 offen sc1
  s_add_u32 s72, s72, 1024
  s_cmp_eq_u32 s72, s71
  s_cselect_b32 s72, s56, s72
  buffer_load_dwordx4 v[136:139], v7, s[36:39], s72 offen sc1
  buffer_load_dwordx4 v[140:143], v8, s[36:39], s72 offen sc1
  s_add_u32 s72, s72, 1024
  s_cmp_eq_u32 s72, s71
  s_cselect_b32 s72, s56, s72
  buffer_load_dwordx4 v[144:147], v7, s[36:39], s72 offen sc1
  buffer_load_dwordx4 v[148:151], v8, s[36:39], s72 offen sc1
  s_add_u32 s72, s72, 1024
  s_cmp_eq_u32 s72, s71
  s_cselect_b32 s72, s56, s72
  buffer_load_dwordx4 v[152:155], v7, s[36:39], s72 offen sc1
  buffer_load_dwordx4 v[156:159], v8, s[36:39], s72 offen sc1
  s_add_u32 s72, s72, 1024
  s_cmp_eq_u32 s72, s71
  s_cselect_b32 s72, s56, s72
  s_waitcnt lgkmcnt(0)
  s_setprio 0
  s_waitcnt vmcnt(14)
  v_mfma_f32_16x16x32_bf16 v[16:19], v[56:59], v[96:99], 0
  ds_read_b64_tr_b16 v[160:161], v3 offset:10240
  ds_read_b64_tr_b16 v[162:163], v3 offset:12800
  v_mfma_f32_16x16x32_bf16 v[36:39], v[56:59], v[100:103], 0
  buffer_load_dwordx4 v[180:183], v7, s[36:39], s72 offen sc1
  ds_read_b64_tr_b16 v[164:165], v3 offset:10272
  v_mfma_f32_16x16x32_bf16 v[20:23], v[60:63], v[96:99], 0
  ds_read_b64_tr_b16 v[166:167], v3 offset:12832
  buffer_load_dwordx4 v[184:187], v8, s[36:39], s72 offen sc1
  s_add_u32 s72, s72, 1024
  s_cmp_eq_u32 s72, s71
  s_cselect_b32 s72, s56, s72
  v_mfma_f32_16x16x32_bf16 v[40:43], v[60:63], v[100:103], 0
  ds_read_b64_tr_b16 v[168:169], v3 offset:10304
  ds_read_b64_tr_b16 v[170:171], v3 offset:12864
  v_mfma_f32_16x16x32_bf16 v[24:27], v[64:67], v[96:99], 0
  buffer_load_dwordx4 v[188:191], v7, s[36:39], s72 offen sc1
  ds_read_b64_tr_b16 v[172:173], v3 offset:10336
  v_mfma_f32_16x16x32_bf16 v[44:47], v[64:67], v[100:103], 0
  ds_read_b64_tr_b16 v[174:175], v3 offset:12896
  buffer_load_dwordx4 v[192:195], v8, s[36:39], s72 offen sc1
  s_add_u32 s72, s72, 1024
  s_cmp_eq_u32 s72, s71
  s_cselect_b32 s72, s56, s72
  v_mfma_f32_16x16x32_bf16 v[28:31], v[68:71], v[96:99], 0
  ds_read_b64_tr_b16 v[176:177], v3 offset:10368
  ds_read_b64_tr_b16 v[178:179], v3 offset:12928
  v_mfma_f32_16x16x32_bf16 v[48:51], v[68:71], v[100:103], 0
  v_mfma_f32_16x16x32_bf16 v[32:35], v[72:75], v[96:99], 0
  v_mfma_f32_16x16x32_bf16 v[52:55], v[72:75], v[100:103], 0
  s_waitcnt vmcnt(16)
  v_mfma_f32_16x16x32_bf16 v[16:19], v[76:79], v[104:107], v[16:19]
  ds_read_b64_tr_b16 v[196:197], v3 offset:15360
  ds_read_b64_tr_b16 v[198:199], v3 offset:17920
  v_mfma_f32_16x16x32_bf16 v[36:39], v[76:79], v[108:111], v[36:39]
  buffer_load_dwordx4 v[220:223], v7, s[36:39], s72 offen sc1
  ds_read_b64_tr_b16 v[204:205], v3 offset:15392
  v_mfma_f32_16x16x32_bf16 v[20:23], v[80:83], v[104:107], v[20:23]
  ds_read_b64_tr_b16 v[206:207], v3 offset:17952
  buffer_load_dwordx4 v[200:203], v8, s[36:39], s72 offen sc1
  s_add_u32 s72, s72, 1024
  s_cmp_eq_u32 s72, s71
  s_cselect_b32 s72, s56, s72
  v_mfma_f32_16x16x32_bf16 v[40:43], v[80:83], v[108:111], v[40:43]
  ds_read_b64_tr_b16 v[208:209], v3 offset:15424
  ds_read_b64_tr_b16 v[210:211], v3 offset:17984
  v_mfma_f32_16x16x32_bf16 v[24:27], v[84:87], v[104:107], v[24:27]
  buffer_load_dwordx4 v[56:59], v7, s[36:39], s72 offen sc1
  ds_read_b64_tr_b16 v[212:213], v3 offset:15456
  v_mfma_f32_16x16x32_bf16 v[44:47], v[84:87], v[108:111], v[44:47]
  ds_read_b64_tr_b16 v[214:215], v3 offset:18016
  buffer_load_dwordx4 v[60:63], v8, s[36:39], s72 offen sc1
  s_add_u32 s72, s72, 1024
  s_cmp_eq_u32 s72, s71
  s_cselect_b32 s72, s56, s72
  v_mfma_f32_16x16x32_bf16 v[28:31], v[88:91], v[104:107], v[28:31]
  ds_read_b64_tr_b16 v[216:217], v3 offset:15488
  ds_read_b64_tr_b16 v[218:219], v3 offset:18048
  v_mfma_f32_16x16x32_bf16 v[48:51], v[88:91], v[108:111], v[48:51]
  v_mfma_f32_16x16x32_bf16 v[32:35], v[92:95], v[104:107], v[32:35]
  v_mfma_f32_16x16x32_bf16 v[52:55], v[92:95], v[108:111], v[52:55]
  s_waitcnt vmcnt(18) lgkmcnt(10)
  v_mfma_f32_16x16x32_bf16 v[16:19], v[160:163], v[112:115], v[16:19]
  ds_read_b64_tr_b16 v[64:65], v4 offset:0
  ds_read_b64_tr_b16 v[66:67], v4 offset:2560
  v_mfma_f32_16x16x32_bf16 v[36:39], v[160:163], v[116:119], v[36:39]
  buffer_load_dwordx4 v[76:79], v7, s[36:39], s72 offen sc1
  ds_read_b64_tr_b16 v[68:69], v4 offset:32
  v_mfma_f32_16x16x32_bf16 v[20:23], v[164:167], v[112:115], v[20:23]
  ds_read_b64_tr_b16 v[70:71], v4 offset:2592
  buffer_load_dwordx4 v[80:83], v8, s[36:39], s72 offen sc1
  s_add_u32 s72, s72, 1024
  s_cmp_eq_u32 s72, s71
  s_cselect_b32 s72, s56, s72
  v_mfma_f32_16x16x32_bf16 v[40:43], v[164:167], v[116:119], v[40:43]
  ds_read_b64_tr_b16 v[72:73], v4 offset:64
  ds_read_b64_tr_b16 v[74:75], v4 offset:2624
  v_mfma_f32_16x16x32_bf16 v[24:27], v[168:171], v[112:115], v[24:27]
  buffer_load_dwordx4 v[84:87], v7, s[36:39], s72 offen sc1
  ds_read_b64_tr_b16 v[96:97], v4 offset:96
  v_mfma_f32_16x16x32_bf16 v[44:47], v[168:171], v[116:119], v[44:47]
  ds_read_b64_tr_b16 v[98:99], v4 offset:2656
  buffer_load_dwordx4 v[88:91], v8, s[36:39], s72 offen sc1
  s_add_u32 s72, s72, 1024
  s_cmp_eq_u32 s72, s71
  s_cselect_b32 s72, s56, s72
  v_mfma_f32_16x16x32_bf16 v[28:31], v[172:175], v[112:115], v[28:31]
  ds_read_b64_tr_b16 v[100:101], v4 offset:128
  ds_read_b64_tr_b16 v[102:103], v4 offset:2688
  v_mfma_f32_16x16x32_bf16 v[48:51], v[172:175], v[116:119], v[48:51]
  v_mfma_f32_16x16x32_bf16 v[32:35], v[176:179], v[112:115], v[32:35]
  v_mfma_f32_16x16x32_bf16 v[52:55], v[176:179], v[116:119], v[52:55]
  s_waitcnt vmcnt(20) lgkmcnt(10)
  v_mfma_f32_16x16x32_bf16 v[16:19], v[196:199], v[120:123], v[16:19]
  ds_read_b64_tr_b16 v[92:93], v4 offset:5120
  ds_read_b64_tr_b16 v[94:95], v4 offset:7680
  v_mfma_f32_16x16x32_bf16 v[36:39], v[196:199], v[124:127], v[36:39]
  s_mov_b32 s47, s72
  buffer_load_dwordx4 v[168:171], v7, s[36:39], s72 offen sc1
  s_add_u32 s72, s72, 1024
  s_cmp_eq_u32 s72, s71
  s_cselect_b32 s72, s56, s72
  ds_read_b64_tr_b16 v[104:105], v4 offset:5152
  v_mfma_f32_16x16x32_bf16 v[20:23], v[204:207], v[120:123], v[20:23]
  ds_read_b64_tr_b16 v[106:107], v4 offset:7712
  buffer_load_dwordx4 v[172:175], v7, s[36:39], s72 offen sc1
  s_add_u32 s72, s72, 1024
  s_cmp_eq_u32 s72, s71
  s_cselect_b32 s72, s56, s72
  v_mfma_f32_16x16x32_bf16 v[40:43], v[204:207], v[124:127], v[40:43]
  ds_read_b64_tr_b16 v[108:109], v4 offset:5184
  ds_read_b64_tr_b16 v[110:111], v4 offset:7744
  v_mfma_f32_16x16x32_bf16 v[24:27], v[208:211], v[120:123], v[24:27]
  buffer_load_dwordx4 v[176:179], v7, s[36:39], s72 offen sc1
  s_add_u32 s72, s72, 1024
  s_cmp_eq_u32 s72, s71
  s_cselect_b32 s72, s56, s72
  ds_read_b64_tr_b16 v[160:161], v4 offset:5216
  v_mfma_f32_16x16x32_bf16 v[44:47], v[208:211], v[124:127], v[44:47]
  ds_read_b64_tr_b16 v[162:163], v4 offset:7776
  buffer_load_dwordx4 v[112:115], v7, s[36:39], s72 offen sc1
  s_add_u32 s72, s72, 1024
  s_cmp_eq_u32 s72, s71
  s_cselect_b32 s72, s56, s72
  v_mfma_f32_16x16x32_bf16 v[28:31], v[212:215], v[120:123], v[28:31]
  ds_read_b64_tr_b16 v[164:165], v4 offset:5248
  ds_read_b64_tr_b16 v[166:167], v4 offset:7808
  v_mfma_f32_16x16x32_bf16 v[48:51], v[212:215], v[124:127], v[48:51]
  v_mfma_f32_16x16x32_bf16 v[32:35], v[216:219], v[120:123], v[32:35]
  v_mfma_f32_16x16x32_bf16 v[52:55], v[216:219], v[124:127], v[52:55]
  s_waitcnt vmcnt(22) lgkmcnt(10)
  v_mfma_f32_16x16x32_bf16 v[16:19], v[64:67], v[128:131], v[16:19]
  ds_read_b64_tr_b16 v[116:117], v4 offset:10240
  ds_read_b64_tr_b16 v[118:119], v4 offset:12800
  v_mfma_f32_16x16x32_bf16 v[36:39], v[64:67], v[132:135], v[36:39]
  buffer_load_dwordx4 v[216:219], v7, s[36:39], s72 offen sc1
  s_add_u32 s72, s72, 1024
  s_cmp_eq_u32 s72, s71
  s_cselect_b32 s72, s56, s72
  ds_read_b64_tr_b16 v[196:197], v4 offset:10272
  v_mfma_f32_16x16x32_bf16 v[20:23], v[68:71], v[128:131], v[20:23]
  ds_read_b64_tr_b16 v[198:199], v4 offset:12832
  buffer_load_dwordx4 v[120:123], v7, s[36:39], s72 offen sc1
  s_add_u32 s72, s72, 1024
  s_cmp_eq_u32 s72, s71
  s_cselect_b32 s72, s56, s72
  v_mfma_f32_16x16x32_bf16 v[40:43], v[68:71], v[132:135], v[40:43]
  ds_read_b64_tr_b16 v[204:205], v4 offset:10304
  ds_read_b64_tr_b16 v[206:207], v4 offset:12864
  v_mfma_f32_16x16x32_bf16 v[24:27], v[72:75], v[128:131], v[24:27]
  buffer_load_dwordx4 v[124:127], v7, s[36:39], s72 offen sc1
  s_add_u32 s72, s72, 1024
  s_cmp_eq_u32 s72, s71
  s_cselect_b32 s72, s56, s72
  ds_read_b64_tr_b16 v[208:209], v4 offset:10336
  v_mfma_f32_16x16x32_bf16 v[44:47], v[72:75], v[132:135], v[44:47]
  ds_read_b64_tr_b16 v[210:211], v4 offset:12896
  ds_read_b64_tr_b16 v[212:213], v4 offset:10368
  v_mfma_f32_16x16x32_bf16 v[28:31], v[96:99], v[128:131], v[28:31]
  ds_read_b64_tr_b16 v[214:215], v4 offset:12928
  v_mfma_f32_16x16x32_bf16 v[48:51], v[96:99], v[132:135], v[48:51]
  v_mfma_f32_16x16x32_bf16 v[32:35], v[100:103], v[128:131], v[32:35]
  v_mfma_f32_16x16x32_bf16 v[52:55], v[100:103], v[132:135], v[52:55]
  s_waitcnt vmcnt(23) lgkmcnt(10)
  s_lshl_b32 s22, s13, 2
  s_add_u32 s22, s22, 163336
  v_mov_b32 v250, s22
  v_mov_b32 v251, 3
  s_mov_b64 exec, 1
  ds_write_b32 v250, v251
  s_mov_b64 exec, -1
  v_mfma_f32_16x16x32_bf16 v[16:19], v[92:95], v[136:139], v[16:19]
  ds_read_b64_tr_b16 v[64:65], v4 offset:15360
  ds_read_b64_tr_b16 v[66:67], v4 offset:17920
  v_mfma_f32_16x16x32_bf16 v[36:39], v[92:95], v[140:143], v[36:39]
  buffer_load_dwordx4 v[128:131], v7, s[36:39], s72 offen sc1
  s_add_u32 s72, s72, 1024
  s_cmp_eq_u32 s72, s71
  s_cselect_b32 s72, s56, s72
  ds_read_b64_tr_b16 v[68:69], v4 offset:15392
  v_mfma_f32_16x16x32_bf16 v[20:23], v[104:107], v[136:139], v[20:23]
  ds_read_b64_tr_b16 v[70:71], v4 offset:17952
  buffer_load_dwordx4 v[132:135], v7, s[36:39], s72 offen sc1
  s_add_u32 s72, s72, 1024
  s_cmp_eq_u32 s72, s71
  s_cselect_b32 s72, s56, s72
  v_mfma_f32_16x16x32_bf16 v[40:43], v[104:107], v[140:143], v[40:43]
  ds_read_b64_tr_b16 v[72:73], v4 offset:15424
  ds_read_b64_tr_b16 v[74:75], v4 offset:17984
  v_mfma_f32_16x16x32_bf16 v[24:27], v[108:111], v[136:139], v[24:27]
  ds_read_b64_tr_b16 v[96:97], v4 offset:15456
  ds_read_b64_tr_b16 v[98:99], v4 offset:18016
  v_mfma_f32_16x16x32_bf16 v[44:47], v[108:111], v[140:143], v[44:47]
  ds_read_b64_tr_b16 v[100:101], v4 offset:15488
  ds_read_b64_tr_b16 v[102:103], v4 offset:18048
  v_mfma_f32_16x16x32_bf16 v[28:31], v[160:163], v[136:139], v[28:31]
  v_mfma_f32_16x16x32_bf16 v[48:51], v[160:163], v[140:143], v[48:51]
  v_mfma_f32_16x16x32_bf16 v[32:35], v[164:167], v[136:139], v[32:35]
  v_mfma_f32_16x16x32_bf16 v[52:55], v[164:167], v[140:143], v[52:55]
  s_waitcnt vmcnt(23) lgkmcnt(11)
  v_mfma_f32_16x16x32_bf16 v[16:19], v[116:119], v[144:147], v[16:19]
  ds_read_b64_tr_b16 v[92:93], v4 offset:20480
  ds_read_b64_tr_b16 v[94:95], v4 offset:23040
  v_mfma_f32_16x16x32_bf16 v[36:39], v[116:119], v[148:151], v[36:39]
  buffer_load_dwordx4 v[136:139], v7, s[36:39], s72 offen sc1
  s_add_u32 s72, s72, 1024
  s_cmp_eq_u32 s72, s71
  s_cselect_b32 s72, s56, s72
  ds_read_b64_tr_b16 v[104:105], v4 offset:20512
  v_mfma_f32_16x16x32_bf16 v[20:23], v[196:199], v[144:147], v[20:23]
  ds_read_b64_tr_b16 v[106:107], v4 offset:23072
  buffer_load_dwordx4 v[140:143], v7, s[36:39], s72 offen sc1
  s_add_u32 s72, s72, 1024
  s_cmp_eq_u32 s72, s71
  s_cselect_b32 s72, s56, s72
  v_mfma_f32_16x16x32_bf16 v[40:43], v[196:199], v[148:151], v[40:43]
  ds_read_b64_tr_b16 v[108:109], v4 offset:20544
  ds_read_b64_tr_b16 v[110:111], v4 offset:23104
  v_mfma_f32_16x16x32_bf16 v[24:27], v[204:207], v[144:147], v[24:27]
  ds_read_b64_tr_b16 v[160:161], v4 offset:20576
  ds_read_b64_tr_b16 v[162:163], v4 offset:23136
  v_mfma_f32_16x16x32_bf16 v[44:47], v[204:207], v[148:151], v[44:47]
  ds_read_b64_tr_b16 v[164:165], v4 offset:20608
  ds_read_b64_tr_b16 v[166:167], v4 offset:23168
  v_mfma_f32_16x16x32_bf16 v[28:31], v[208:211], v[144:147], v[28:31]
  v_mfma_f32_16x16x32_bf16 v[48:51], v[208:211], v[148:151], v[48:51]
  v_mfma_f32_16x16x32_bf16 v[32:35], v[212:215], v[144:147], v[32:35]
  v_mfma_f32_16x16x32_bf16 v[52:55], v[212:215], v[148:151], v[52:55]
  s_waitcnt vmcnt(23) lgkmcnt(10)
  v_mfma_f32_16x16x32_bf16 v[16:19], v[64:67], v[152:155], v[16:19]
  ds_read_b32 v6, v5
  ds_read_b64_tr_b16 v[116:117], v4 offset:25600
  v_mfma_f32_16x16x32_bf16 v[36:39], v[64:67], v[156:159], v[36:39]
  buffer_load_dwordx4 v[144:147], v7, s[36:39], s72 offen sc1
  s_add_u32 s72, s72, 1024
  s_cmp_eq_u32 s72, s71
  s_cselect_b32 s72, s56, s72
  ds_read_b64_tr_b16 v[118:119], v4 offset:28160
  v_mfma_f32_16x16x32_bf16 v[20:23], v[68:71], v[152:155], v[20:23]
  ds_read_b64_tr_b16 v[196:197], v4 offset:25632
  buffer_load_dwordx4 v[148:151], v7, s[36:39], s72 offen sc1
  s_add_u32 s72, s72, 1024
  s_cmp_eq_u32 s72, s71
  s_cselect_b32 s72, s56, s72
  v_mfma_f32_16x16x32_bf16 v[40:43], v[68:71], v[156:159], v[40:43]
  ds_read_b64_tr_b16 v[198:199], v4 offset:28192
  ds_read_b64_tr_b16 v[204:205], v4 offset:25664
  v_mfma_f32_16x16x32_bf16 v[24:27], v[72:75], v[152:155], v[24:27]
  ds_read_b64_tr_b16 v[206:207], v4 offset:28224
  ds_read_b64_tr_b16 v[208:209], v4 offset:25696
  v_mfma_f32_16x16x32_bf16 v[44:47], v[72:75], v[156:159], v[44:47]
  ds_read_b64_tr_b16 v[210:211], v4 offset:28256
  ds_read_b64_tr_b16 v[212:213], v4 offset:25728
  v_mfma_f32_16x16x32_bf16 v[28:31], v[96:99], v[152:155], v[28:31]
  ds_read_b64_tr_b16 v[214:215], v4 offset:28288
  v_mfma_f32_16x16x32_bf16 v[48:51], v[96:99], v[156:159], v[48:51]
  v_mfma_f32_16x16x32_bf16 v[32:35], v[100:103], v[152:155], v[32:35]
  v_mfma_f32_16x16x32_bf16 v[52:55], v[100:103], v[156:159], v[52:55]
  s_waitcnt vmcnt(23) lgkmcnt(10)
  v_cmp_gt_u32 vcc, 16, v6
  s_cbranch_vccnz MS_33
MR_34:
  v_mfma_f32_16x16x32_bf16 v[16:19], v[92:95], v[180:183], v[16:19]
  ds_read_b64_tr_b16 v[64:65], v4 offset:30720
  ds_read_b64_tr_b16 v[66:67], v4 offset:33280
  v_mfma_f32_16x16x32_bf16 v[36:39], v[92:95], v[184:187], v[36:39]
  buffer_load_dwordx4 v[152:155], v7, s[36:39], s72 offen sc1
  s_add_u32 s72, s72, 1024
  s_cmp_eq_u32 s72, s71
  s_cselect_b32 s72, s56, s72
  ds_read_b64_tr_b16 v[68:69], v4 offset:30752
  v_mfma_f32_16x16x32_bf16 v[20:23], v[104:107], v[180:183], v[20:23]
  ds_read_b64_tr_b16 v[70:71], v4 offset:33312
  ds_read_b64_tr_b16 v[72:73], v4 offset:30784
  v_mfma_f32_16x16x32_bf16 v[40:43], v[104:107], v[184:187], v[40:43]
  ds_read_b64_tr_b16 v[74:75], v4 offset:33344
  ds_read_b64_tr_b16 v[96:97], v4 offset:30816
  v_mfma_f32_16x16x32_bf16 v[24:27], v[108:111], v[180:183], v[24:27]
  ds_read_b64_tr_b16 v[98:99], v4 offset:33376
  ds_read_b64_tr_b16 v[100:101], v4 offset:30848
  v_mfma_f32_16x16x32_bf16 v[44:47], v[108:111], v[184:187], v[44:47]
  ds_read_b64_tr_b16 v[102:103], v4 offset:33408
  v_mfma_f32_16x16x32_bf16 v[28:31], v[160:163], v[180:183], v[28:31]
  v_mfma_f32_16x16x32_bf16 v[48:51], v[160:163], v[184:187], v[48:51]
  v_mfma_f32_16x16x32_bf16 v[32:35], v[164:167], v[180:183], v[32:35]
  v_mfma_f32_16x16x32_bf16 v[52:55], v[164:167], v[184:187], v[52:55]
  s_waitcnt vmcnt(22) lgkmcnt(10)
  v_mfma_f32_16x16x32_bf16 v[16:19], v[116:119], v[188:191], v[16:19]
  ds_read_b64_tr_b16 v[156:157], v4 offset:35840
  v_mfma_f32_16x16x32_bf16 v[36:39], v[116:119], v[192:195], v[36:39]
  ds_read_b64_tr_b16 v[158:159], v4 offset:38400
  v_mfma_f32_16x16x32_bf16 v[20:23], v[196:199], v[188:191], v[20:23]
  ds_read_b64_tr_b16 v[92:93], v4 offset:35872
  v_mfma_f32_16x16x32_bf16 v[40:43], v[196:199], v[192:195], v[40:43]
  ds_read_b64_tr_b16 v[94:95], v4 offset:38432
  v_mfma_f32_16x16x32_bf16 v[24:27], v[204:207], v[188:191], v[24:27]
  ds_read_b64_tr_b16 v[104:105], v4 offset:35904
  v_mfma_f32_16x16x32_bf16 v[44:47], v[204:207], v[192:195], v[44:47]
  ds_read_b64_tr_b16 v[106:107], v4 offset:38464
  v_mfma_f32_16x16x32_bf16 v[28:31], v[208:211], v[188:191], v[28:31]
  ds_read_b64_tr_b16 v[108:109], v4 offset:35936
  v_mfma_f32_16x16x32_bf16 v[48:51], v[208:211], v[192:195], v[48:51]
  ds_read_b64_tr_b16 v[110:111], v4 offset:38496
  v_mfma_f32_16x16x32_bf16 v[32:35], v[212:215], v[188:191], v[32:35]
  ds_read_b64_tr_b16 v[160:161], v4 offset:35968
  v_mfma_f32_16x16x32_bf16 v[52:55], v[212:215], v[192:195], v[52:55]
  ds_read_b64_tr_b16 v[162:163], v4 offset:38528
  s_waitcnt vmcnt(20) lgkmcnt(10)
  s_lshl_b32 s22, s13, 2
  s_add_u32 s22, s22, 163336
  v_mov_b32 v250, s22
  v_mov_b32 v251, 4
  s_mov_b64 exec, 1
  ds_write_b32 v250, v251
  s_mov_b64 exec, -1
  v_mfma_f32_16x16x32_bf16 v[16:19], v[64:67], v[220:223], v[16:19]
  ds_read_b64_tr_b16 v[164:165], v4 offset:40960
  v_mfma_f32_16x16x32_bf16 v[36:39], v[64:67], v[200:203], v[36:39]
  ds_read_b64_tr_b16 v[166:167], v4 offset:43520
  v_mfma_f32_16x16x32_bf16 v[20:23], v[68:71], v[220:223], v[20:23]
  ds_read_b64_tr_b16 v[180:181], v4 offset:40992
  v_mfma_f32_16x16x32_bf16 v[40:43], v[68:71], v[200:203], v[40:43]
  ds_read_b64_tr_b16 v[182:183], v4 offset:43552
  v_mfma_f32_16x16x32_bf16 v[24:27], v[72:75], v[220:223], v[24:27]
  ds_read_b64_tr_b16 v[184:185], v4 offset:41024
  v_mfma_f32_16x16x32_bf16 v[44:47], v[72:75], v[200:203], v[44:47]
  ds_read_b64_tr_b16 v[186:187], v4 offset:43584
  v_mfma_f32_16x16x32_bf16 v[28:31], v[96:99], v[220:223], v[28:31]
  ds_read_b64_tr_b16 v[116:117], v4 offset:41056
  v_mfma_f32_16x16x32_bf16 v[48:51], v[96:99], v[200:203], v[48:51]
  ds_read_b64_tr_b16 v[118:119], v4 offset:43616
  v_mfma_f32_16x16x32_bf16 v[32:35], v[100:103], v[220:223], v[32:35]
  ds_read_b64_tr_b16 v[196:197], v4 offset:41088
  v_mfma_f32_16x16x32_bf16 v[52:55], v[100:103], v[200:203], v[52:55]
  ds_read_b64_tr_b16 v[198:199], v4 offset:43648
  s_waitcnt vmcnt(18) lgkmcnt(11)
  v_mfma_f32_16x16x32_bf16 v[16:19], v[156:159], v[56:59], v[16:19]
  ds_read_b64_tr_b16 v[204:205], v4 offset:46080
  v_mfma_f32_16x16x32_bf16 v[36:39], v[156:159], v[60:63], v[36:39]
  ds_read_b64_tr_b16 v[206:207], v4 offset:48640
  v_mfma_f32_16x16x32_bf16 v[20:23], v[92:95], v[56:59], v[20:23]
  ds_read_b64_tr_b16 v[208:209], v4 offset:46112
  v_mfma_f32_16x16x32_bf16 v[40:43], v[92:95], v[60:63], v[40:43]
  ds_read_b64_tr_b16 v[210:211], v4 offset:48672
  v_mfma_f32_16x16x32_bf16 v[24:27], v[104:107], v[56:59], v[24:27]
  ds_read_b64_tr_b16 v[212:213], v4 offset:46144
  v_mfma_f32_16x16x32_bf16 v[44:47], v[104:107], v[60:63], v[44:47]
  ds_read_b64_tr_b16 v[214:215], v4 offset:48704
  v_mfma_f32_16x16x32_bf16 v[28:31], v[108:111], v[56:59], v[28:31]
  ds_read_b64_tr_b16 v[188:189], v4 offset:46176
  v_mfma_f32_16x16x32_bf16 v[48:51], v[108:111], v[60:63], v[48:51]
  ds_read_b64_tr_b16 v[190:191], v4 offset:48736
  v_mfma_f32_16x16x32_bf16 v[32:35], v[160:163], v[56:59], v[32:35]
  ds_read_b64_tr_b16 v[192:193], v4 offset:46208
  v_mfma_f32_16x16x32_bf16 v[52:55], v[160:163], v[60:63], v[52:55]
  ds_read_b64_tr_b16 v[194:195], v4 offset:48768
  s_waitcnt vmcnt(16) lgkmcnt(10)
  v_mfma_f32_16x16x32_bf16 v[16:19], v[164:167], v[76:79], v[16:19]
  ds_read_b64_tr_b16 v[64:65], v4 offset:51200
  v_mfma_f32_16x16x32_bf16 v[36:39], v[164:167], v[80:83], v[36:39]
  ds_read_b64_tr_b16 v[66:67], v4 offset:53760
  v_mfma_f32_16x16x32_bf16 v[20:23], v[180:183], v[76:79], v[20:23]
  ds_read_b64_tr_b16 v[68:69], v4 offset:51232
  v_mfma_f32_16x16x32_bf16 v[40:43], v[180:183], v[80:83], v[40:43]
  ds_read_b64_tr_b16 v[70:71], v4 offset:53792
  v_mfma_f32_16x16x32_bf16 v[24:27], v[184:187], v[76:79], v[24:27]
  ds_read_b64_tr_b16 v[72:73], v4 offset:51264
  v_mfma_f32_16x16x32_bf16 v[44:47], v[184:187], v[80:83], v[44:47]
  ds_read_b64_tr_b16 v[74:75], v4 offset:53824
  v_mfma_f32_16x16x32_bf16 v[28:31], v[116:119], v[76:79], v[28:31]
  ds_read_b64_tr_b16 v[96:97], v4 offset:51296
  v_mfma_f32_16x16x32_bf16 v[48:51], v[116:119], v[80:83], v[48:51]
  ds_read_b64_tr_b16 v[98:99], v4 offset:53856
  v_mfma_f32_16x16x32_bf16 v[32:35], v[196:199], v[76:79], v[32:35]
  ds_read_b64_tr_b16 v[100:101], v4 offset:51328
  v_mfma_f32_16x16x32_bf16 v[52:55], v[196:199], v[80:83], v[52:55]
  ds_read_b64_tr_b16 v[102:103], v4 offset:53888
  s_waitcnt vmcnt(14) lgkmcnt(10)
  v_mfma_f32_16x16x32_bf16 v[16:19], v[204:207], v[84:87], v[16:19]
  ds_read_b32 v6, v5
  ds_read_b64_tr_b16 v[220:221], v4 offset:56320
  v_mfma_f32_16x16x32_bf16 v[36:39], v[204:207], v[88:91], v[36:39]
  ds_read_b64_tr_b16 v[222:223], v4 offset:58880
  ds_read_b64_tr_b16 v[200:201], v4 offset:56352
  v_mfma_f32_16x16x32_bf16 v[20:23], v[208:211], v[84:87], v[20:23]
  ds_read_b64_tr_b16 v[202:203], v4 offset:58912
  ds_read_b64_tr_b16 v[156:157], v4 offset:56384
  v_mfma_f32_16x16x32_bf16 v[40:43], v[208:211], v[88:91], v[40:43]
  ds_read_b64_tr_b16 v[158:159], v4 offset:58944
  ds_read_b64_tr_b16 v[92:93], v4 offset:56416
  v_mfma_f32_16x16x32_bf16 v[24:27], v[212:215], v[84:87], v[24:27]
  ds_read_b64_tr_b16 v[94:95], v4 offset:58976
  ds_read_b64_tr_b16 v[104:105], v4 offset:56448
  v_mfma_f32_16x16x32_bf16 v[44:47], v[212:215], v[88:91], v[44:47]
  ds_read_b64_tr_b16 v[106:107], v4 offset:59008
  v_mfma_f32_16x16x32_bf16 v[28:31], v[188:191], v[84:87], v[28:31]
  v_mfma_f32_16x16x32_bf16 v[48:51], v[188:191], v[88:91], v[48:51]
  v_mfma_f32_16x16x32_bf16 v[32:35], v[192:195], v[84:87], v[32:35]
  v_mfma_f32_16x16x32_bf16 v[52:55], v[192:195], v[88:91], v[52:55]
  s_waitcnt vmcnt(13) lgkmcnt(10)
  v_cmp_gt_u32 vcc, 22, v6
  s_cbranch_vccnz MS_35
MR_36:
  v_mfma_f32_16x16x32_bf16 v[16:19], v[64:67], v[168:171], v[16:19]
  ds_read_b64_tr_b16 v[108:109], v9 offset:0
  ds_read_b64_tr_b16 v[110:111], v9 offset:2560
  v_mfma_f32_16x16x32_bf16 v[20:23], v[68:71], v[168:171], v[20:23]
  ds_read_b64_tr_b16 v[160:161], v9 offset:32
  ds_read_b64_tr_b16 v[162:163], v9 offset:2592
  v_mfma_f32_16x16x32_bf16 v[24:27], v[72:75], v[168:171], v[24:27]
  ds_read_b64_tr_b16 v[56:57], v9 offset:64
  ds_read_b64_tr_b16 v[58:59], v9 offset:2624
  v_mfma_f32_16x16x32_bf16 v[28:31], v[96:99], v[168:171], v[28:31]
  ds_read_b64_tr_b16 v[60:61], v9 offset:96
  ds_read_b64_tr_b16 v[62:63], v9 offset:2656
  v_mfma_f32_16x16x32_bf16 v[32:35], v[100:103], v[168:171], v[32:35]
  ds_read_b64_tr_b16 v[164:165], v9 offset:128
  ds_read_b64_tr_b16 v[166:167], v9 offset:2688
  s_waitcnt vmcnt(12) lgkmcnt(10)
  v_mfma_f32_16x16x32_bf16 v[16:19], v[220:223], v[172:175], v[16:19]
  ds_read_b64_tr_b16 v[180:181], v9 offset:5120
  ds_read_b64_tr_b16 v[182:183], v9 offset:7680
  v_mfma_f32_16x16x32_bf16 v[20:23], v[200:203], v[172:175], v[20:23]
  ds_read_b64_tr_b16 v[184:185], v9 offset:5152
  ds_read_b64_tr_b16 v[186:187], v9 offset:7712
  v_mfma_f32_16x16x32_bf16 v[24:27], v[156:159], v[172:175], v[24:27]
  ds_read_b64_tr_b16 v[116:117], v9 offset:5184
  ds_read_b64_tr_b16 v[118:119], v9 offset:7744
  v_mfma_f32_16x16x32_bf16 v[28:31], v[92:95], v[172:175], v[28:31]
  ds_read_b64_tr_b16 v[196:197], v9 offset:5216
  ds_read_b64_tr_b16 v[198:199], v9 offset:7776
  v_mfma_f32_16x16x32_bf16 v[32:35], v[104:107], v[172:175], v[32:35]
  ds_read_b64_tr_b16 v[76:77], v9 offset:5248
  ds_read_b64_tr_b16 v[78:79], v9 offset:7808
  s_waitcnt vmcnt(11) lgkmcnt(10)
  v_mfma_f32_16x16x32_bf16 v[16:19], v[108:111], v[176:179], v[16:19]
  ds_read_b64_tr_b16 v[80:81], v9 offset:10240
  ds_read_b64_tr_b16 v[82:83], v9 offset:12800
  v_mfma_f32_16x16x32_bf16 v[20:23], v[160:163], v[176:179], v[20:23]
  ds_read_b64_tr_b16 v[204:205], v9 offset:10272
  ds_read_b64_tr_b16 v[206:207], v9 offset:12832
  v_mfma_f32_16x16x32_bf16 v[24:27], v[56:59], v[176:179], v[24:27]
  ds_read_b64_tr_b16 v[208:209], v9 offset:10304
  ds_read_b64_tr_b16 v[210:211], v9 offset:12864
  v_mfma_f32_16x16x32_bf16 v[28:31], v[60:63], v[176:179], v[28:31]
  ds_read_b64_tr_b16 v[212:213], v9 offset:10336
  ds_read_b64_tr_b16 v[214:215], v9 offset:12896
  v_mfma_f32_16x16x32_bf16 v[32:35], v[164:167], v[176:179], v[32:35]
  ds_read_b64_tr_b16 v[188:189], v9 offset:10368
  ds_read_b64_tr_b16 v[190:191], v9 offset:12928
  s_waitcnt vmcnt(10) lgkmcnt(10)
  v_mfma_f32_16x16x32_bf16 v[16:19], v[180:183], v[112:115], v[16:19]
  ds_read_b64_tr_b16 v[192:193], v9 offset:15360
  ds_read_b64_tr_b16 v[194:195], v9 offset:17920
  v_mfma_f32_16x16x32_bf16 v[20:23], v[184:187], v[112:115], v[20:23]
  ds_read_b64_tr_b16 v[84:85], v9 offset:15392
  ds_read_b64_tr_b16 v[86:87], v9 offset:17952
  v_mfma_f32_16x16x32_bf16 v[24:27], v[116:119], v[112:115], v[24:27]
  ds_read_b64_tr_b16 v[88:89], v9 offset:15424
  ds_read_b64_tr_b16 v[90:91], v9 offset:17984
  v_mfma_f32_16x16x32_bf16 v[28:31], v[196:199], v[112:115], v[28:31]
  ds_read_b64_tr_b16 v[64:65], v9 offset:15456
  ds_read_b64_tr_b16 v[66:67], v9 offset:18016
  v_mfma_f32_16x16x32_bf16 v[32:35], v[76:79], v[112:115], v[32:35]
  ds_read_b64_tr_b16 v[68:69], v9 offset:15488
  ds_read_b64_tr_b16 v[70:71], v9 offset:18048
  s_waitcnt vmcnt(9) lgkmcnt(10)
  v_mfma_f32_16x16x32_bf16 v[16:19], v[80:83], v[216:219], v[16:19]
  ds_read_b64_tr_b16 v[72:73], v9 offset:20480
  ds_read_b64_tr_b16 v[74:75], v9 offset:23040
  s_mov_b32 s72, s47
  buffer_load_dwordx4 v[200:203], v8, s[36:39], s72 offen sc1
  s_add_u32 s72, s72, 1024
  s_cmp_eq_u32 s72, s71
  s_cselect_b32 s72, s56, s72
  v_mfma_f32_16x16x32_bf16 v[20:23], v[204:207], v[216:219], v[20:23]
  ds_read_b64_tr_b16 v[96:97], v9 offset:20512
  ds_read_b64_tr_b16 v[98:99], v9 offset:23072
  buffer_load_dwordx4 v[156:159], v8, s[36:39], s72 offen sc1
  s_add_u32 s72, s72, 1024
  s_cmp_eq_u32 s72, s71
  s_cselect_b32 s72, s56, s72
  v_mfma_f32_16x16x32_bf16 v[24:27], v[208:211], v[216:219], v[24:27]
  ds_read_b64_tr_b16 v[100:101], v9 offset:20544
  ds_read_b64_tr_b16 v[102:103], v9 offset:23104
  ds_read_b64_tr_b16 v[168:169], v9 offset:20576
  v_mfma_f32_16x16x32_bf16 v[28:31], v[212:215], v[216:219], v[28:31]
  ds_read_b64_tr_b16 v[170:171], v9 offset:23136
  ds_read_b64_tr_b16 v[220:221], v9 offset:20608
  ds_read_b64_tr_b16 v[222:223], v9 offset:23168
  v_mfma_f32_16x16x32_bf16 v[32:35], v[188:191], v[216:219], v[32:35]
  s_waitcnt vmcnt(10) lgkmcnt(10)
  v_mfma_f32_16x16x32_bf16 v[16:19], v[192:195], v[120:123], v[16:19]
  ds_read_b32 v6, v5
  ds_read_b64_tr_b16 v[92:93], v9 offset:25600
  buffer_load_dwordx4 v[56:59], v8, s[36:39], s72 offen sc1
  s_add_u32 s72, s72, 1024
  s_cmp_eq_u32 s72, s71
  s_cselect_b32 s72, s56, s72
  v_mfma_f32_16x16x32_bf16 v[20:23], v[84:87], v[120:123], v[20:23]
  ds_read_b64_tr_b16 v[94:95], v9 offset:28160
  ds_read_b64_tr_b16 v[104:105], v9 offset:25632
  buffer_load_dwordx4 v[60:63], v8, s[36:39], s72 offen sc1
  s_add_u32 s72, s72, 1024
  s_cmp_eq_u32 s72, s71
  s_cselect_b32 s72, s56, s72
  v_mfma_f32_16x16x32_bf16 v[24:27], v[88:91], v[120:123], v[24:27]
  ds_read_b64_tr_b16 v[106:107], v9 offset:28192
  ds_read_b64_tr_b16 v[172:173], v9 offset:25664
  ds_read_b64_tr_b16 v[174:175], v9 offset:28224
  v_mfma_f32_16x16x32_bf16 v[28:31], v[64:67], v[120:123], v[28:31]
  ds_read_b64_tr_b16 v[108:109], v9 offset:25696
  ds_read_b64_tr_b16 v[110:111], v9 offset:28256
  ds_read_b64_tr_b16 v[160:161], v9 offset:25728
  v_mfma_f32_16x16x32_bf16 v[32:35], v[68:71], v[120:123], v[32:35]
  ds_read_b64_tr_b16 v[162:163], v9 offset:28288
  s_waitcnt vmcnt(11) lgkmcnt(10)
  v_cmp_gt_u32 vcc, 28, v6
  s_cbranch_vccnz MS_37
MR_38:
  v_mfma_f32_16x16x32_bf16 v[16:19], v[72:75], v[124:127], v[16:19]
  ds_read_b64_tr_b16 v[164:165], v3 offset:0
  ds_read_b64_tr_b16 v[166:167], v3 offset:2560
  buffer_load_dwordx4 v[196:199], v8, s[36:39], s72 offen sc1
  s_add_u32 s72, s72, 1024
  s_cmp_eq_u32 s72, s71
  s_cselect_b32 s72, s56, s72
  v_mfma_f32_16x16x32_bf16 v[20:23], v[96:99], v[124:127], v[20:23]
  ds_read_b64_tr_b16 v[176:177], v3 offset:32
  ds_read_b64_tr_b16 v[178:179], v3 offset:2592
  buffer_load_dwordx4 v[76:79], v8, s[36:39], s72 offen sc1
  s_add_u32 s72, s72, 1024
  s_cmp_eq_u32 s72, s71
  s_cselect_b32 s72, s56, s72
  v_mfma_f32_16x16x32_bf16 v[24:27], v[100:103], v[124:127], v[24:27]
  ds_read_b64_tr_b16 v[180:181], v3 offset:64
  ds_read_b64_tr_b16 v[182:183], v3 offset:2624
  ds_read_b64_tr_b16 v[184:185], v3 offset:96
  v_mfma_f32_16x16x32_bf16 v[28:31], v[168:171], v[124:127], v[28:31]
  ds_read_b64_tr_b16 v[186:187], v3 offset:2656
  ds_read_b64_tr_b16 v[116:117], v3 offset:128
  ds_read_b64_tr_b16 v[118:119], v3 offset:2688
  v_mfma_f32_16x16x32_bf16 v[32:35], v[220:223], v[124:127], v[32:35]
  s_waitcnt vmcnt(12) lgkmcnt(10)
  v_mfma_f32_16x16x32_bf16 v[16:19], v[92:95], v[128:131], v[16:19]
  ds_read_b64_tr_b16 v[112:113], v3 offset:5120
  ds_read_b64_tr_b16 v[114:115], v3 offset:7680
  buffer_load_dwordx4 v[188:191], v8, s[36:39], s72 offen sc1
  s_add_u32 s72, s72, 1024
  s_cmp_eq_u32 s72, s71
  s_cselect_b32 s72, s56, s72
  v_mfma_f32_16x16x32_bf16 v[20:23], v[104:107], v[128:131], v[20:23]
  ds_read_b64_tr_b16 v[80:81], v3 offset:5152
  ds_read_b64_tr_b16 v[82:83], v3 offset:7712
  buffer_load_dwordx4 v[216:219], v8, s[36:39], s72 offen sc1
  s_add_u32 s72, s72, 1024
  s_cmp_eq_u32 s72, s71
  s_cselect_b32 s72, s56, s72
  v_mfma_f32_16x16x32_bf16 v[24:27], v[172:175], v[128:131], v[24:27]
  ds_read_b64_tr_b16 v[204:205], v3 offset:5184
  ds_read_b64_tr_b16 v[206:207], v3 offset:7744
  ds_read_b64_tr_b16 v[208:209], v3 offset:5216
  v_mfma_f32_16x16x32_bf16 v[28:31], v[108:111], v[128:131], v[28:31]
  ds_read_b64_tr_b16 v[210:211], v3 offset:7776
  ds_read_b64_tr_b16 v[212:213], v3 offset:5248
  ds_read_b64_tr_b16 v[214:215], v3 offset:7808
  v_mfma_f32_16x16x32_bf16 v[32:35], v[160:163], v[128:131], v[32:35]
  s_waitcnt vmcnt(13) lgkmcnt(10)
  v_mfma_f32_16x16x32_bf16 v[16:19], v[164:167], v[132:135], v[16:19]
  ds_read_b64_tr_b16 v[192:193], v3 offset:10240
  ds_read_b64_tr_b16 v[194:195], v3 offset:12800
  buffer_load_dwordx4 v[120:123], v8, s[36:39], s72 offen sc1
  s_add_u32 s72, s72, 1024
  s_cmp_eq_u32 s72, s71
  s_cselect_b32 s72, s56, s72
  v_mfma_f32_16x16x32_bf16 v[20:23], v[176:179], v[132:135], v[20:23]
  ds_read_b64_tr_b16 v[84:85], v3 offset:10272
  ds_read_b64_tr_b16 v[86:87], v3 offset:12832
  buffer_load_dwordx4 v[72:75], v8, s[36:39], s72 offen sc1
  s_add_u32 s72, s72, 1024
  s_cmp_eq_u32 s72, s71
  s_cselect_b32 s72, s56, s72
  v_mfma_f32_16x16x32_bf16 v[24:27], v[180:183], v[132:135], v[24:27]
  ds_read_b64_tr_b16 v[88:89], v3 offset:10304
  ds_read_b64_tr_b16 v[90:91], v3 offset:12864
  ds_read_b64_tr_b16 v[64:65], v3 offset:10336
  v_mfma_f32_16x16x32_bf16 v[28:31], v[184:187], v[132:135], v[28:31]
  ds_read_b64_tr_b16 v[66:67], v3 offset:12896
  ds_read_b64_tr_b16 v[68:69], v3 offset:10368
  ds_read_b64_tr_b16 v[70:71], v3 offset:12928
  v_mfma_f32_16x16x32_bf16 v[32:35], v[116:119], v[132:135], v[32:35]
  s_waitcnt vmcnt(14) lgkmcnt(10)
  v_mfma_f32_16x16x32_bf16 v[16:19], v[112:115], v[136:139], v[16:19]
  ds_read_b64_tr_b16 v[96:97], v3 offset:15360
  ds_read_b64_tr_b16 v[98:99], v3 offset:17920
  buffer_load_dwordx4 v[92:95], v8, s[36:39], s72 offen sc1
  s_add_u32 s72, s72, 1024
  s_cmp_eq_u32 s72, s71
  s_cselect_b32 s72, s56, s72
  v_mfma_f32_16x16x32_bf16 v[20:23], v[80:83], v[136:139], v[20:23]
  ds_read_b64_tr_b16 v[100:101], v3 offset:15392
  ds_read_b64_tr_b16 v[102:103], v3 offset:17952
  buffer_load_dwordx4 v[104:107], v8, s[36:39], s72 offen sc1
  s_add_u32 s72, s72, 1024
  s_cmp_eq_u32 s72, s71
  s_cselect_b32 s72, s56, s72
  v_mfma_f32_16x16x32_bf16 v[24:27], v[204:207], v[136:139], v[24:27]
  ds_read_b64_tr_b16 v[168:169], v3 offset:15424
  ds_read_b64_tr_b16 v[170:171], v3 offset:17984
  ds_read_b64_tr_b16 v[220:221], v3 offset:15456
  v_mfma_f32_16x16x32_bf16 v[28:31], v[208:211], v[136:139], v[28:31]
  ds_read_b64_tr_b16 v[222:223], v3 offset:18016
  ds_read_b64_tr_b16 v[124:125], v3 offset:15488
  ds_read_b64_tr_b16 v[126:127], v3 offset:18048
  v_mfma_f32_16x16x32_bf16 v[32:35], v[212:215], v[136:139], v[32:35]
  s_waitcnt vmcnt(15) lgkmcnt(10)
  v_mfma_f32_16x16x32_bf16 v[16:19], v[192:195], v[140:143], v[16:19]
  ds_read_b64_tr_b16 v[172:173], v4 offset:0
  ds_read_b64_tr_b16 v[174:175], v4 offset:2560
  buffer_load_dwordx4 v[176:179], v8, s[36:39], s72 offen sc1
  s_add_u32 s72, s72, 1024
  s_cmp_eq_u32 s72, s71
  s_cselect_b32 s72, s56, s72
  v_mfma_f32_16x16x32_bf16 v[20:23], v[84:87], v[140:143], v[20:23]
  ds_read_b64_tr_b16 v[108:109], v4 offset:32
  ds_read_b64_tr_b16 v[110:111], v4 offset:2592
  buffer_load_dwordx4 v[180:183], v8, s[36:39], s72 offen sc1
  s_add_u32 s72, s72, 1024
  s_cmp_eq_u32 s72, s71
  s_cselect_b32 s72, s56, s72
  v_mfma_f32_16x16x32_bf16 v[24:27], v[88:91], v[140:143], v[24:27]
  ds_read_b64_tr_b16 v[160:161], v4 offset:64
  ds_read_b64_tr_b16 v[162:163], v4 offset:2624
  ds_read_b64_tr_b16 v[128:129], v4 offset:96
  v_mfma_f32_16x16x32_bf16 v[28:31], v[64:67], v[140:143], v[28:31]
  ds_read_b64_tr_b16 v[130:131], v4 offset:2656
  ds_read_b64_tr_b16 v[164:165], v4 offset:128
  ds_read_b64_tr_b16 v[166:167], v4 offset:2688
  v_mfma_f32_16x16x32_bf16 v[32:35], v[68:71], v[140:143], v[32:35]
  s_waitcnt vmcnt(16) lgkmcnt(10)
  v_mfma_f32_16x16x32_bf16 v[16:19], v[96:99], v[144:147], v[16:19]
  ds_read_b64_tr_b16 v[184:185], v4 offset:5120
  ds_read_b64_tr_b16 v[186:187], v4 offset:7680
  v_mfma_f32_16x16x32_bf16 v[20:23], v[100:103], v[144:147], v[20:23]
  ds_read_b64_tr_b16 v[116:117], v4 offset:5152
  ds_read_b64_tr_b16 v[118:119], v4 offset:7712
  v_mfma_f32_16x16x32_bf16 v[24:27], v[168:171], v[144:147], v[24:27]
  ds_read_b64_tr_b16 v[132:133], v4 offset:5184
  ds_read_b64_tr_b16 v[134:135], v4 offset:7744
  v_mfma_f32_16x16x32_bf16 v[28:31], v[220:223], v[144:147], v[28:31]
  ds_read_b64_tr_b16 v[112:113], v4 offset:5216
  ds_read_b64_tr_b16 v[114:115], v4 offset:7776
  v_mfma_f32_16x16x32_bf16 v[32:35], v[124:127], v[144:147], v[32:35]
  ds_read_b64_tr_b16 v[80:81], v4 offset:5248
  ds_read_b64_tr_b16 v[82:83], v4 offset:7808
  s_waitcnt vmcnt(15) lgkmcnt(10)
  v_mfma_f32_16x16x32_bf16 v[16:19], v[172:175], v[148:151], v[16:19]
  ds_read_b64_tr_b16 v[204:205], v4 offset:51200
  ds_read_b64_tr_b16 v[206:207], v4 offset:53760
  v_mfma_f32_16x16x32_bf16 v[20:23], v[108:111], v[148:151], v[20:23]
  ds_read_b64_tr_b16 v[208:209], v4 offset:51232
  ds_read_b64_tr_b16 v[210:211], v4 offset:53792
  v_mfma_f32_16x16x32_bf16 v[24:27], v[160:163], v[148:151], v[24:27]
  ds_read_b64_tr_b16 v[212:213], v4 offset:51264
  ds_read_b64_tr_b16 v[214:215], v4 offset:53824
  v_mfma_f32_16x16x32_bf16 v[28:31], v[128:131], v[148:151], v[28:31]
  ds_read_b64_tr_b16 v[136:137], v4 offset:51296
  ds_read_b64_tr_b16 v[138:139], v4 offset:53856
  v_mfma_f32_16x16x32_bf16 v[32:35], v[164:167], v[148:151], v[32:35]
  ds_read_b64_tr_b16 v[192:193], v4 offset:51328
  ds_read_b64_tr_b16 v[194:195], v4 offset:53888
  s_waitcnt vmcnt(14) lgkmcnt(10)
  v_mfma_f32_16x16x32_bf16 v[16:19], v[184:187], v[152:155], v[16:19]
  ds_read_b64_tr_b16 v[84:85], v4 offset:56320
  ds_read_b64_tr_b16 v[86:87], v4 offset:58880
  v_mfma_f32_16x16x32_bf16 v[20:23], v[116:119], v[152:155], v[20:23]
  ds_read_b64_tr_b16 v[88:89], v4 offset:56352
  ds_read_b64_tr_b16 v[90:91], v4 offset:58912
  v_mfma_f32_16x16x32_bf16 v[24:27], v[132:135], v[152:155], v[24:27]
  ds_read_b64_tr_b16 v[64:65], v4 offset:56384
  ds_read_b64_tr_b16 v[66:67], v4 offset:58944
  v_mfma_f32_16x16x32_bf16 v[28:31], v[112:115], v[152:155], v[28:31]
  ds_read_b64_tr_b16 v[68:69], v4 offset:56416
  ds_read_b64_tr_b16 v[70:71], v4 offset:58976
  v_mfma_f32_16x16x32_bf16 v[32:35], v[80:83], v[152:155], v[32:35]
  ds_read_b64_tr_b16 v[140:141], v4 offset:56448
  ds_read_b64_tr_b16 v[142:143], v4 offset:59008
  s_waitcnt vmcnt(13) lgkmcnt(10)
  v_mfma_f32_16x16x32_bf16 v[36:39], v[204:207], v[200:203], v[36:39]
  ds_read_b64_tr_b16 v[96:97], v9 offset:0
  ds_read_b64_tr_b16 v[98:99], v9 offset:2560
  ds_read_b64_tr_b16 v[100:101], v9 offset:32
  v_mfma_f32_16x16x32_bf16 v[40:43], v[208:211], v[200:203], v[40:43]
  ds_read_b64_tr_b16 v[102:103], v9 offset:2592
  ds_read_b64_tr_b16 v[168:169], v9 offset:64
  ds_read_b64_tr_b16 v[170:171], v9 offset:2624
  v_mfma_f32_16x16x32_bf16 v[44:47], v[212:215], v[200:203], v[44:47]
  ds_read_b64_tr_b16 v[220:221], v9 offset:96
  ds_read_b64_tr_b16 v[222:223], v9 offset:2656
  ds_read_b64_tr_b16 v[124:125], v9 offset:128
  v_mfma_f32_16x16x32_bf16 v[48:51], v[136:139], v[200:203], v[48:51]
  ds_read_b64_tr_b16 v[126:127], v9 offset:2688
  ds_read_b32 v6, v12
  v_mfma_f32_16x16x32_bf16 v[52:55], v[192:195], v[200:203], v[52:55]
  v_cvt_pk_bf16_f32 v16, v16, v17
  v_cvt_pk_bf16_f32 v17, v18, v19
  v_cvt_pk_bf16_f32 v18, v20, v21
  v_mov_b32 v19, s100
  buffer_store_dwordx4 v[16:19], v2, s[36:39], s66 offen offset:0 sc1
  v_cvt_pk_bf16_f32 v20, v22, v23
  v_cvt_pk_bf16_f32 v21, v24, v25
  v_cvt_pk_bf16_f32 v22, v26, v27
  v_mov_b32 v23, s100
  buffer_store_dwordx4 v[20:23], v2, s[36:39], s66 offen offset:1024 sc1
  v_cvt_pk_bf16_f32 v24, v28, v29
  v_cvt_pk_bf16_f32 v25, v30, v31
  v_cvt_pk_bf16_f32 v26, v32, v33
  v_mov_b32 v27, s100
  buffer_store_dwordx4 v[24:27], v2, s[36:39], s66 offen offset:2048 sc1
  v_cvt_pk_bf16_f32 v28, v34, v35
  v_mov_b32 v31, s100
  buffer_store_dwordx4 v[28:31], v2, s[36:39], s66 offen offset:3072 sc1
  s_waitcnt vmcnt(16) lgkmcnt(11)
  v_mfma_f32_16x16x32_bf16 v[36:39], v[84:87], v[156:159], v[36:39]
  ds_read_b64_tr_b16 v[144:145], v9 offset:5120
  ds_read_b64_tr_b16 v[146:147], v9 offset:7680
  v_mfma_f32_16x16x32_bf16 v[40:43], v[88:91], v[156:159], v[40:43]
  ds_read_b64_tr_b16 v[172:173], v9 offset:5152
  ds_read_b64_tr_b16 v[174:175], v9 offset:7712
  v_mfma_f32_16x16x32_bf16 v[44:47], v[64:67], v[156:159], v[44:47]
  ds_read_b64_tr_b16 v[108:109], v9 offset:5184
  ds_read_b64_tr_b16 v[110:111], v9 offset:7744
  v_mfma_f32_16x16x32_bf16 v[48:51], v[68:71], v[156:159], v[48:51]
  ds_read_b64_tr_b16 v[160:161], v9 offset:5216
  ds_read_b64_tr_b16 v[162:163], v9 offset:7776
  v_mfma_f32_16x16x32_bf16 v[52:55], v[140:143], v[156:159], v[52:55]
  ds_read_b64_tr_b16 v[128:129], v9 offset:5248
  ds_read_b64_tr_b16 v[130:131], v9 offset:7808
  s_waitcnt vmcnt(15) lgkmcnt(10)
  v_cmp_gt_u32 vcc, 4, v6
  s_cbranch_vccnz MS_39
MR_40:
  v_mfma_f32_16x16x32_bf16 v[36:39], v[96:99], v[56:59], v[36:39]
  ds_read_b64_tr_b16 v[164:165], v9 offset:10240
  ds_read_b64_tr_b16 v[166:167], v9 offset:12800
  ds_read_b64_tr_b16 v[148:149], v9 offset:10272
  v_mfma_f32_16x16x32_bf16 v[40:43], v[100:103], v[56:59], v[40:43]
  ds_read_b64_tr_b16 v[150:151], v9 offset:12832
  ds_read_b64_tr_b16 v[184:185], v9 offset:10304
  ds_read_b64_tr_b16 v[186:187], v9 offset:12864
  v_mfma_f32_16x16x32_bf16 v[44:47], v[168:171], v[56:59], v[44:47]
  ds_read_b64_tr_b16 v[116:117], v9 offset:10336
  ds_read_b64_tr_b16 v[118:119], v9 offset:12896
  ds_read_b64_tr_b16 v[132:133], v9 offset:10368
  v_mfma_f32_16x16x32_bf16 v[48:51], v[220:223], v[56:59], v[48:51]
  ds_read_b64_tr_b16 v[134:135], v9 offset:12928
  buffer_load_dword v252, v254, s[36:39], s73 offen sc1
  s_add_u32 m0, s60, 0
  s_nop 0
  buffer_load_dwordx4 v240, s[24:27], s58 offen lds
  s_add_u32 m0, s60, 1024
  s_nop 0
  buffer_load_dwordx4 v241, s[24:27], s58 offen lds
  s_mov_b32 exec_hi, 0
  s_add_u32 m0, s60, 2048
  s_nop 0
  buffer_load_dwordx4 v242, s[24:27], s58 offen lds
  s_mov_b64 exec, -1
  s_mul_i32 s22, s45, 160
  buffer_load_dwordx2 v[224:225], v14, s[52:55], s22 offen offset:0
  buffer_load_dwordx2 v[226:227], v14, s[52:55], s22 offen offset:32
  buffer_load_dwordx2 v[228:229], v14, s[52:55], s22 offen offset:64
  buffer_load_dwordx2 v[230:231], v14, s[52:55], s22 offen offset:96
  buffer_load_dwordx2 v[232:233], v14, s[52:55], s22 offen offset:128
  v_mfma_f32_16x16x32_bf16 v[52:55], v[124:127], v[56:59], v[52:55]
  s_waitcnt vmcnt(23) lgkmcnt(10)
  v_mfma_f32_16x16x32_bf16 v[36:39], v[144:147], v[60:63], v[36:39]
  ds_read_b64_tr_b16 v[112:113], v9 offset:15360
  ds_read_b64_tr_b16 v[114:115], v9 offset:17920
  v_mfma_f32_16x16x32_bf16 v[40:43], v[172:175], v[60:63], v[40:43]
  ds_read_b64_tr_b16 v[80:81], v9 offset:15392
  ds_read_b64_tr_b16 v[82:83], v9 offset:17952
  v_mfma_f32_16x16x32_bf16 v[44:47], v[108:111], v[60:63], v[44:47]
  ds_read_b64_tr_b16 v[152:153], v9 offset:15424
  ds_read_b64_tr_b16 v[154:155], v9 offset:17984
  v_mfma_f32_16x16x32_bf16 v[48:51], v[160:163], v[60:63], v[48:51]
  ds_read_b64_tr_b16 v[204:205], v9 offset:15456
  ds_read_b64_tr_b16 v[206:207], v9 offset:18016
  v_mfma_f32_16x16x32_bf16 v[52:55], v[128:131], v[60:63], v[52:55]
  ds_read_b64_tr_b16 v[208:209], v9 offset:15488
  ds_read_b64_tr_b16 v[210:211], v9 offset:18048
  s_waitcnt vmcnt(22) lgkmcnt(10)
  v_mfma_f32_16x16x32_bf16 v[36:39], v[164:167], v[196:199], v[36:39]
  ds_read_b64_tr_b16 v[212:213], v9 offset:20480
  ds_read_b64_tr_b16 v[214:215], v9 offset:23040
  v_mfma_f32_16x16x32_bf16 v[40:43], v[148:151], v[196:199], v[40:43]
  ds_read_b64_tr_b16 v[136:137], v9 offset:20512
  ds_read_b64_tr_b16 v[138:139], v9 offset:23072
  v_mfma_f32_16x16x32_bf16 v[44:47], v[184:187], v[196:199], v[44:47]
  ds_read_b64_tr_b16 v[192:193], v9 offset:20544
  ds_read_b64_tr_b16 v[194:195], v9 offset:23104
  v_mfma_f32_16x16x32_bf16 v[48:51], v[116:119], v[196:199], v[48:51]
  ds_read_b64_tr_b16 v[200:201], v9 offset:20576
  ds_read_b64_tr_b16 v[202:203], v9 offset:23136
  v_mfma_f32_16x16x32_bf16 v[52:55], v[132:135], v[196:199], v[52:55]
  ds_read_b64_tr_b16 v[84:85], v9 offset:20608
  ds_read_b64_tr_b16 v[86:87], v9 offset:23168
  s_waitcnt vmcnt(21) lgkmcnt(10)
  v_mfma_f32_16x16x32_bf16 v[36:39], v[112:115], v[76:79], v[36:39]
  ds_read_b64_tr_b16 v[88:89], v9 offset:25600
  ds_read_b64_tr_b16 v[90:91], v9 offset:28160
  v_mfma_f32_16x16x32_bf16 v[40:43], v[80:83], v[76:79], v[40:43]
  ds_read_b64_tr_b16 v[64:65], v9 offset:25632
  ds_read_b64_tr_b16 v[66:67], v9 offset:28192
  v_mfma_f32_16x16x32_bf16 v[44:47], v[152:155], v[76:79], v[44:47]
  ds_read_b64_tr_b16 v[68:69], v9 offset:25664
  ds_read_b64_tr_b16 v[70:71], v9 offset:28224
  v_mfma_f32_16x16x32_bf16 v[48:51], v[204:207], v[76:79], v[48:51]
  ds_read_b64_tr_b16 v[140:141], v9 offset:25696
  ds_read_b64_tr_b16 v[142:143], v9 offset:28256
  v_mfma_f32_16x16x32_bf16 v[52:55], v[208:211], v[76:79], v[52:55]
  ds_read_b64_tr_b16 v[156:157], v9 offset:25728
  ds_read_b64_tr_b16 v[158:159], v9 offset:28288
  s_waitcnt vmcnt(20) lgkmcnt(10)
  v_mfma_f32_16x16x32_bf16 v[36:39], v[212:215], v[188:191], v[36:39]
  ds_read_b64_tr_b16 v[96:97], v3 offset:0
  ds_read_b64_tr_b16 v[98:99], v3 offset:2560
  v_mfma_f32_16x16x32_bf16 v[40:43], v[136:139], v[188:191], v[40:43]
  ds_read_b64_tr_b16 v[100:101], v3 offset:32
  ds_read_b64_tr_b16 v[102:103], v3 offset:2592
  v_mfma_f32_16x16x32_bf16 v[44:47], v[192:195], v[188:191], v[44:47]
  ds_read_b64_tr_b16 v[168:169], v3 offset:64
  ds_read_b64_tr_b16 v[170:171], v3 offset:2624
  v_mfma_f32_16x16x32_bf16 v[48:51], v[200:203], v[188:191], v[48:51]
  ds_read_b64_tr_b16 v[220:221], v3 offset:96
  ds_read_b64_tr_b16 v[222:223], v3 offset:2656
  v_mfma_f32_16x16x32_bf16 v[52:55], v[84:87], v[188:191], v[52:55]
  ds_read_b64_tr_b16 v[124:125], v3 offset:128
  ds_read_b64_tr_b16 v[126:127], v3 offset:2688
  s_waitcnt vmcnt(8)
  v_cmp_ne_u32 vcc, s100, v252
  s_nop 2
  s_or_b32 s65, vcc_lo, vcc_hi
  s_cmp_eq_u32 s65, 0
  s_cselect_b32 s70, s61, 0x7f000000
  s_add_u32 m0, s60, 2560
  s_nop 0
  buffer_load_dwordx4 v11, s[36:39], s70 offen sc1 lds
  s_add_u32 s70, s70, 32768
  s_add_u32 m0, s60, 3584
  s_nop 0
  buffer_load_dwordx4 v11, s[36:39], s70 offen sc1 lds
  s_add_u32 s70, s70, 32768
  s_mov_b32 exec_hi, 0
  s_add_u32 m0, s60, 4608
  s_nop 0
  buffer_load_dwordx4 v11, s[36:39], s70 offen sc1 lds
  s_mov_b64 exec, -1
  s_waitcnt lgkmcnt(10)
  v_mfma_f32_16x16x32_bf16 v[36:39], v[88:91], v[216:219], v[36:39]
  ds_read_b64_tr_b16 v[56:57], v3 offset:5120
  ds_read_b64_tr_b16 v[58:59], v3 offset:7680
  v_mfma_f32_16x16x32_bf16 v[40:43], v[64:67], v[216:219], v[40:43]
  ds_read_b64_tr_b16 v[144:145], v3 offset:5152
  ds_read_b64_tr_b16 v[146:147], v3 offset:7712
  v_mfma_f32_16x16x32_bf16 v[44:47], v[68:71], v[216:219], v[44:47]
  ds_read_b64_tr_b16 v[172:173], v3 offset:5184
  ds_read_b64_tr_b16 v[174:175], v3 offset:7744
  v_mfma_f32_16x16x32_bf16 v[48:51], v[140:143], v[216:219], v[48:51]
  ds_read_b64_tr_b16 v[108:109], v3 offset:5216
  ds_read_b64_tr_b16 v[110:111], v3 offset:7776
  v_mfma_f32_16x16x32_bf16 v[52:55], v[156:159], v[216:219], v[52:55]
  ds_read_b64_tr_b16 v[160:161], v3 offset:5248
  ds_read_b64_tr_b16 v[162:163], v3 offset:7808
  s_waitcnt lgkmcnt(10)
  v_mfma_f32_16x16x32_bf16 v[36:39], v[96:99], v[120:123], v[36:39]
  ds_read_b64_tr_b16 v[128:129], v3 offset:10240
  ds_read_b64_tr_b16 v[130:131], v3 offset:12800
  v_mfma_f32_16x16x32_bf16 v[40:43], v[100:103], v[120:123], v[40:43]
  ds_read_b64_tr_b16 v[60:61], v3 offset:10272
  ds_read_b64_tr_b16 v[62:63], v3 offset:12832
  v_mfma_f32_16x16x32_bf16 v[44:47], v[168:171], v[120:123], v[44:47]
  ds_read_b64_tr_b16 v[164:165], v3 offset:10304
  ds_read_b64_tr_b16 v[166:167], v3 offset:12864
  v_mfma_f32_16x16x32_bf16 v[48:51], v[220:223], v[120:123], v[48:51]
  ds_read_b64_tr_b16 v[148:149], v3 offset:10336
  ds_read_b64_tr_b16 v[150:151], v3 offset:12896
  v_mfma_f32_16x16x32_bf16 v[52:55], v[124:127], v[120:123], v[52:55]
  ds_read_b64_tr_b16 v[184:185], v3 offset:10368
  ds_read_b64_tr_b16 v[186:187], v3 offset:12928
  s_waitcnt lgkmcnt(10)
  v_mfma_f32_16x16x32_bf16 v[36:39], v[56:59], v[72:75], v[36:39]
  ds_read_b64_tr_b16 v[116:117], v3 offset:15360
  ds_read_b64_tr_b16 v[118:119], v3 offset:17920
  v_mfma_f32_16x16x32_bf16 v[40:43], v[144:147], v[72:75], v[40:43]
  ds_read_b64_tr_b16 v[132:133], v3 offset:15392
  ds_read_b64_tr_b16 v[134:135], v3 offset:17952
  v_mfma_f32_16x16x32_bf16 v[44:47], v[172:175], v[72:75], v[44:47]
  ds_read_b64_tr_b16 v[196:197], v3 offset:15424
  ds_read_b64_tr_b16 v[198:199], v3 offset:17984
  v_mfma_f32_16x16x32_bf16 v[48:51], v[108:111], v[72:75], v[48:51]
  ds_read_b64_tr_b16 v[112:113], v3 offset:15456
  ds_read_b64_tr_b16 v[114:115], v3 offset:18016
  v_mfma_f32_16x16x32_bf16 v[52:55], v[160:163], v[72:75], v[52:55]
  ds_read_b64_tr_b16 v[80:81], v3 offset:15488
  ds_read_b64_tr_b16 v[82:83], v3 offset:18048
  s_waitcnt lgkmcnt(10)
  v_mfma_f32_16x16x32_bf16 v[36:39], v[128:131], v[92:95], v[36:39]
  ds_read_b64_tr_b16 v[152:153], v4 offset:0
  ds_read_b64_tr_b16 v[154:155], v4 offset:2560
  v_mfma_f32_16x16x32_bf16 v[40:43], v[60:63], v[92:95], v[40:43]
  ds_read_b64_tr_b16 v[204:205], v4 offset:32
  ds_read_b64_tr_b16 v[206:207], v4 offset:2592
  v_mfma_f32_16x16x32_bf16 v[44:47], v[164:167], v[92:95], v[44:47]
  ds_read_b64_tr_b16 v[208:209], v4 offset:64
  ds_read_b64_tr_b16 v[210:211], v4 offset:2624
  v_mfma_f32_16x16x32_bf16 v[48:51], v[148:151], v[92:95], v[48:51]
  ds_read_b64_tr_b16 v[76:77], v4 offset:96
  ds_read_b64_tr_b16 v[78:79], v4 offset:2656
  v_mfma_f32_16x16x32_bf16 v[52:55], v[184:187], v[92:95], v[52:55]
  ds_read_b64_tr_b16 v[212:213], v4 offset:128
  ds_read_b64_tr_b16 v[214:215], v4 offset:2688
  s_waitcnt lgkmcnt(10)
  v_mfma_f32_16x16x32_bf16 v[36:39], v[116:119], v[104:107], v[36:39]
  ds_read_b64_tr_b16 v[136:137], v4 offset:5120
  ds_read_b64_tr_b16 v[138:139], v4 offset:7680
  v_mfma_f32_16x16x32_bf16 v[40:43], v[132:135], v[104:107], v[40:43]
  ds_read_b64_tr_b16 v[192:193], v4 offset:5152
  ds_read_b64_tr_b16 v[194:195], v4 offset:7712
  v_mfma_f32_16x16x32_bf16 v[44:47], v[196:199], v[104:107], v[44:47]
  ds_read_b64_tr_b16 v[200:201], v4 offset:5184
  ds_read_b64_tr_b16 v[202:203], v4 offset:7744
  v_mfma_f32_16x16x32_bf16 v[48:51], v[112:115], v[104:107], v[48:51]
  ds_read_b64_tr_b16 v[84:85], v4 offset:5216
  ds_read_b64_tr_b16 v[86:87], v4 offset:7776
  v_mfma_f32_16x16x32_bf16 v[52:55], v[80:83], v[104:107], v[52:55]
  ds_read_b64_tr_b16 v[188:189], v4 offset:5248
  ds_read_b64_tr_b16 v[190:191], v4 offset:7808
  s_waitcnt lgkmcnt(10)
  v_mfma_f32_16x16x32_bf16 v[36:39], v[152:155], v[176:179], v[36:39]
  v_mfma_f32_16x16x32_bf16 v[40:43], v[204:207], v[176:179], v[40:43]
  v_mfma_f32_16x16x32_bf16 v[44:47], v[208:211], v[176:179], v[44:47]
  v_mfma_f32_16x16x32_bf16 v[48:51], v[76:79], v[176:179], v[48:51]
  v_mfma_f32_16x16x32_bf16 v[52:55], v[212:215], v[176:179], v[52:55]
  s_waitcnt lgkmcnt(0)
  v_mfma_f32_16x16x32_bf16 v[36:39], v[136:139], v[180:183], v[36:39]
  v_mfma_f32_16x16x32_bf16 v[40:43], v[192:195], v[180:183], v[40:43]
  v_mfma_f32_16x16x32_bf16 v[44:47], v[200:203], v[180:183], v[44:47]
  v_mfma_f32_16x16x32_bf16 v[48:51], v[84:87], v[180:183], v[48:51]
  v_mfma_f32_16x16x32_bf16 v[52:55], v[188:191], v[180:183], v[52:55]
  s_mov_b32 s59, 0xffff0000
  s_waitcnt vmcnt(3)
  s_cmp_eq_u32 s65, 0
  s_cbranch_scc1 Y_OK
  s_branch PF_42
PG_41:
  s_sleep 4
PF_42:
  buffer_load_dword v252, v254, s[36:39], s73 offen sc1
  s_waitcnt vmcnt(0)
  v_cmp_ne_u32 vcc, s100, v252
  s_cbranch_vccz CT_43
  s_add_u32 s79, s79, 1
  s_cmp_lt_u32 s79, 20000
  s_cbranch_scc1 PG_41
CT_43:
  s_add_u32 m0, s60, 2560
  s_nop 0
  buffer_load_dwordx4 v11, s[36:39], s61 offen sc1 lds
  s_add_u32 s61, s61, 32768
  s_add_u32 m0, s60, 3584
  s_nop 0
  buffer_load_dwordx4 v11, s[36:39], s61 offen sc1 lds
  s_add_u32 s61, s61, 32768
  s_mov_b32 exec_hi, 0
  s_add_u32 m0, s60, 4608
  s_nop 0
  buffer_load_dwordx4 v11, s[36:39], s61 offen sc1 lds
  s_mov_b64 exec, -1
Y_OK:
  buffer_load_dwordx4 v[128:131], v2, s[36:39], s67 offen offset:0 sc1
  buffer_load_dwordx4 v[132:135], v2, s[36:39], s67 offen offset:1024 sc1
  buffer_load_dwordx4 v[136:139], v2, s[36:39], s67 offen offset:2048 sc1
  buffer_load_dwordx4 v[140:143], v2, s[36:39], s67 offen offset:3072 sc1
  ds_read_b64 v[56:57], v13 offset:0
  ds_read_b64 v[58:59], v13 offset:32
  ds_read_b64 v[60:61], v13 offset:64
  ds_read_b64 v[62:63], v13 offset:96
  ds_read_b64 v[64:65], v13 offset:128
  v_lshlrev_b32 v236, 16, v224
  v_and_b32 v237, s59, v224
  v_lshlrev_b32 v238, 16, v225
  v_and_b32 v239, s59, v225
  v_add_f32 v36, v36, v236
  v_add_f32 v37, v37, v237
  v_add_f32 v38, v38, v238
  v_add_f32 v39, v39, v239
  v_lshlrev_b32 v236, 16, v226
  v_and_b32 v237, s59, v226
  v_lshlrev_b32 v238, 16, v227
  v_and_b32 v239, s59, v227
  v_add_f32 v40, v40, v236
  v_add_f32 v41, v41, v237
  v_add_f32 v42, v42, v238
  v_add_f32 v43, v43, v239
  v_lshlrev_b32 v236, 16, v228
  v_and_b32 v237, s59, v228
  v_lshlrev_b32 v238, 16, v229
  v_and_b32 v239, s59, v229
  v_add_f32 v44, v44, v236
  v_add_f32 v45, v45, v237
  v_add_f32 v46, v46, v238
  v_add_f32 v47, v47, v239
  v_lshlrev_b32 v236, 16, v230
  v_and_b32 v237, s59, v230
  v_lshlrev_b32 v238, 16, v231
  v_and_b32 v239, s59, v231
  v_add_f32 v48, v48, v236
  v_add_f32 v49, v49, v237
  v_add_f32 v50, v50, v238
  v_add_f32 v51, v51, v239
  v_lshlrev_b32 v236, 16, v232
  v_and_b32 v237, s59, v232
  v_lshlrev_b32 v238, 16, v233
  v_and_b32 v239, s59, v233
  v_add_f32 v52, v52, v236
  v_add_f32 v53, v53, v237
  v_add_f32 v54, v54, v238
  v_add_f32 v55, v55, v239
  s_waitcnt lgkmcnt(4)
  v_lshlrev_b32 v236, 16, v56
  v_and_b32 v237, s59, v56
  v_lshlrev_b32 v238, 16, v57
  v_and_b32 v239, s59, v57
  v_add_f32 v36, v36, v236
  v_add_f32 v37, v37, v237
  v_add_f32 v38, v38, v238
  v_add_f32 v39, v39, v239
  s_waitcnt lgkmcnt(3)
  v_lshlrev_b32 v236, 16, v58
  v_and_b32 v237, s59, v58
  v_lshlrev_b32 v238, 16, v59
  v_and_b32 v239, s59, v59
  v_add_f32 v40, v40, v236
  v_add_f32 v41, v41, v237
  v_add_f32 v42, v42, v238
  v_add_f32 v43, v43, v239
  s_waitcnt lgkmcnt(2)
  v_lshlrev_b32 v236, 16, v60
  v_and_b32 v237, s59, v60
  v_lshlrev_b32 v238, 16, v61
  v_and_b32 v239, s59, v61
  v_add_f32 v44, v44, v236
  v_add_f32 v45, v45, v237
  v_add_f32 v46, v46, v238
  v_add_f32 v47, v47, v239
  s_waitcnt lgkmcnt(1)
  v_lshlrev_b32 v236, 16, v62
  v_and_b32 v237, s59, v62
  v_lshlrev_b32 v238, 16, v63
  v_and_b32 v239, s59, v63
  v_add_f32 v48, v48, v236
  v_add_f32 v49, v49, v237
  v_add_f32 v50, v50, v238
  v_add_f32 v51, v51, v239
  s_waitcnt lgkmcnt(0)
  v_lshlrev_b32 v236, 16, v64
  v_and_b32 v237, s59, v64
  v_lshlrev_b32 v238, 16, v65
  v_and_b32 v239, s59, v65
  v_add_f32 v52, v52, v236
  v_add_f32 v53, v53, v237
  v_add_f32 v54, v54, v238
  v_add_f32 v55, v55, v239
  s_waitcnt vmcnt(4)
  s_barrier
  ds_read_b64_tr_b16 v[70:71], v243
  ds_read_b64_tr_b16 v[72:73], v244
  ds_read_b64_tr_b16 v[74:75], v245
  ds_read_b64_tr_b16 v[76:77], v246
  ds_read_b64_tr_b16 v[78:79], v247
  s_waitcnt lgkmcnt(4)
  v_lshlrev_b32 v236, 16, v70
  v_and_b32 v237, s59, v70
  v_lshlrev_b32 v238, 16, v71
  v_and_b32 v239, s59, v71
  v_add_f32 v36, v36, v236
  v_add_f32 v37, v37, v237
  v_add_f32 v38, v38, v238
  v_add_f32 v39, v39, v239
  s_waitcnt lgkmcnt(3)
  v_lshlrev_b32 v236, 16, v72
  v_and_b32 v237, s59, v72
  v_lshlrev_b32 v238, 16, v73
  v_and_b32 v239, s59, v73
  v_add_f32 v40, v40, v236
  v_add_f32 v41, v41, v237
  v_add_f32 v42, v42, v238
  v_add_f32 v43, v43, v239
  s_waitcnt lgkmcnt(2)
  v_lshlrev_b32 v236, 16, v74
  v_and_b32 v237, s59, v74
  v_lshlrev_b32 v238, 16, v75
  v_and_b32 v239, s59, v75
  v_add_f32 v44, v44, v236
  v_add_f32 v45, v45, v237
  v_add_f32 v46, v46, v238
  v_add_f32 v47, v47, v239
  s_waitcnt lgkmcnt(1)
  v_lshlrev_b32 v236, 16, v76
  v_and_b32 v237, s59, v76
  v_lshlrev_b32 v238, 16, v77
  v_and_b32 v239, s59, v77
  v_add_f32 v48, v48, v236
  v_add_f32 v49, v49, v237
  v_add_f32 v50, v50, v238
  v_add_f32 v51, v51, v239
  s_waitcnt lgkmcnt(0)
  v_lshlrev_b32 v236, 16, v78
  v_and_b32 v237, s59, v78
  v_lshlrev_b32 v238, 16, v79
  v_and_b32 v239, s59, v79
  v_add_f32 v52, v52, v236
  v_add_f32 v53, v53, v237
  v_add_f32 v54, v54, v238
  v_add_f32 v55, v55, v239
  s_branch PF_45
PG_44:
  s_sleep 0
  buffer_load_dwordx4 v[128:131], v2, s[36:39], s67 offen offset:0 sc1
  buffer_load_dwordx4 v[132:135], v2, s[36:39], s67 offen offset:1024 sc1
  buffer_load_dwordx4 v[136:139], v2, s[36:39], s67 offen offset:2048 sc1
  buffer_load_dwordx4 v[140:143], v2, s[36:39], s67 offen offset:3072 sc1
PF_45:
  s_waitcnt vmcnt(0)
  v_cmp_ne_u32 vcc, s100, v131
  v_cmp_ne_u32 s[62:63], s100, v135
  s_nop 2
  s_or_b64 vcc, vcc, s[62:63]
  v_cmp_ne_u32 s[62:63], s100, v139
  s_nop 2
  s_or_b64 vcc, vcc, s[62:63]
  v_cmp_ne_u32 s[62:63], s100, v143
  s_nop 2
  s_or_b64 vcc, vcc, s[62:63]
  s_cbranch_vccz CT_46
  s_add_u32 s79, s79, 1
  s_cmp_lt_u32 s79, 20000
  s_cbranch_scc1 PG_44
CT_46:
  v_lshlrev_b32 v236, 16, v128
  v_and_b32 v237, s59, v128
  v_lshlrev_b32 v238, 16, v129
  v_and_b32 v239, s59, v129
  v_add_f32 v36, v36, v236
  v_add_f32 v37, v37, v237
  v_add_f32 v38, v38, v238
  v_add_f32 v39, v39, v239
  v_cvt_pk_bf16_f32 v150, v36, v37
  v_cvt_pk_bf16_f32 v151, v38, v39
  ds_write_b64 v13, v[150:151] offset:0
  v_lshlrev_b32 v236, 16, v130
  v_and_b32 v237, s59, v130
  v_lshlrev_b32 v238, 16, v132
  v_and_b32 v239, s59, v132
  v_add_f32 v40, v40, v236
  v_add_f32 v41, v41, v237
  v_add_f32 v42, v42, v238
  v_add_f32 v43, v43, v239
  v_cvt_pk_bf16_f32 v152, v40, v41
  v_cvt_pk_bf16_f32 v153, v42, v43
  ds_write_b64 v13, v[152:153] offset:32
  v_lshlrev_b32 v236, 16, v133
  v_and_b32 v237, s59, v133
  v_lshlrev_b32 v238, 16, v134
  v_and_b32 v239, s59, v134
  v_add_f32 v44, v44, v236
  v_add_f32 v45, v45, v237
  v_add_f32 v46, v46, v238
  v_add_f32 v47, v47, v239
  v_cvt_pk_bf16_f32 v154, v44, v45
  v_cvt_pk_bf16_f32 v155, v46, v47
  ds_write_b64 v13, v[154:155] offset:64
  v_lshlrev_b32 v236, 16, v136
  v_and_b32 v237, s59, v136
  v_lshlrev_b32 v238, 16, v137
  v_and_b32 v239, s59, v137
  v_add_f32 v48, v48, v236
  v_add_f32 v49, v49, v237
  v_add_f32 v50, v50, v238
  v_add_f32 v51, v51, v239
  v_cvt_pk_bf16_f32 v156, v48, v49
  v_cvt_pk_bf16_f32 v157, v50, v51
  ds_write_b64 v13, v[156:157] offset:96
  v_lshlrev_b32 v236, 16, v138
  v_and_b32 v237, s59, v138
  v_lshlrev_b32 v238, 16, v140
  v_and_b32 v239, s59, v140
  v_add_f32 v52, v52, v236
  v_add_f32 v53, v53, v237
  v_add_f32 v54, v54, v238
  v_add_f32 v55, v55, v239
  v_cvt_pk_bf16_f32 v158, v52, v53
  v_cvt_pk_bf16_f32 v159, v54, v55
  ds_write_b64 v13, v[158:159] offset:128
  ds_read_b128 v[164:167], v253 offset:0
  ds_read_b128 v[168:171], v253 offset:1024
  ds_read_b128 v[172:175], v253 offset:2048
  s_waitcnt lgkmcnt(2)
  buffer_store_dwordx4 v[164:167], v240, s[48:51], s58 offen
  s_waitcnt lgkmcnt(1)
  buffer_store_dwordx4 v[168:171], v241, s[48:51], s58 offen
  s_waitcnt lgkmcnt(0)
  s_mov_b32 exec_hi, 0
  buffer_store_dwordx4 v[172:175], v242, s[48:51], s58 offen
  s_mov_b64 exec, -1
  s_or_b32 s22, s2, s12
  s_cmp_lg_u32 s22, 0
  s_cbranch_scc1 G_NOR
  v_and_b32 v3, 7, v1
  v_lshlrev_b32 v3, 7, v3
  s_mov_b32 s59, 27271168
  s_branch PF_48
PG_47:
  s_sleep 4
PF_48:
  buffer_load_dword v4, v3, s[36:39], s59 offen sc1
  s_waitcnt vmcnt(0)
  v_cmp_ne_u32 vcc, s100, v4
  s_cbranch_vccz CT_49
  s_add_u32 s79, s79, 1
  s_cmp_lt_u32 s79, 20000
  s_cbranch_scc1 PG_47
CT_49:
  s_mov_b32 s22, 27262976
  v_mov_b32 v4, s100
  v_mov_b32 v5, 0
  s_mov_b64 exec, 1
  buffer_store_dword v4, v5, s[36:39], s22 offen sc1
  s_mov_b64 exec, -1
G_NOR:
  s_endpgm
MS_33:
SG_50:
  ds_read_b32 v6, v5
  s_waitcnt lgkmcnt(0)
  v_cmp_gt_u32 vcc, 16, v6
  s_cbranch_vccz SO_51
  s_sleep 1
  s_add_u32 s79, s79, 1
  s_cmp_lt_u32 s79, 200000
  s_cbranch_scc1 SG_50
SO_51:
  s_branch MR_34
MS_35:
SG_52:
  ds_read_b32 v6, v5
  s_waitcnt lgkmcnt(0)
  v_cmp_gt_u32 vcc, 22, v6
  s_cbranch_vccz SO_53
  s_sleep 1
  s_add_u32 s79, s79, 1
  s_cmp_lt_u32 s79, 200000
  s_cbranch_scc1 SG_52
SO_53:
  s_branch MR_36
MS_37:
SG_54:
  ds_read_b32 v6, v5
  s_waitcnt lgkmcnt(0)
  v_cmp_gt_u32 vcc, 28, v6
  s_cbranch_vccz SO_55
  s_sleep 1
  s_add_u32 s79, s79, 1
  s_cmp_lt_u32 s79, 200000
  s_cbranch_scc1 SG_54
SO_55:
  s_branch MR_38
MS_39:
SG_56:
  ds_read_b32 v6, v12
  s_waitcnt lgkmcnt(0)
  v_cmp_gt_u32 vcc, 4, v6
  s_cbranch_vccz SO_57
  s_sleep 1
  s_add_u32 s79, s79, 1
  s_cmp_lt_u32 s79, 200000
  s_cbranch_scc1 SG_56
SO_57:
  s_branch MR_40
G_SKIP:
  s_waitcnt vmcnt(0)
  s_mov_b32 s22, 9
G_BL:
  s_barrier
  s_sub_u32 s22, s22, 1
  s_cmp_lg_u32 s22, 0
  s_cbranch_scc1 G_BL
  s_lshl_b32 s22, s13, 2
  s_add_u32 s22, s22, 163336
  v_mov_b32 v250, s22
  v_mov_b32 v251, 2
  s_mov_b64 exec, 1
  ds_write_b32 v250, v251
  s_mov_b64 exec, -1
  s_branch G2
GC:
  s_setprio 2
  s_mov_b32 s40, s52
  s_and_b32 s41, s53, 0xffff
  s_mov_b32 s42, 2211840
  s_mov_b32 s43, 0x20000
  s_lshl_b32 s18, s44, 2
  s_add_u32 s18, s18, s13
  s_mul_i32 s22, s18, 17408
  v_lshlrev_b32 v8, 7, v1
  s_mul_i32 s22, s18, 17408
  buffer_load_dword v234, v8, s[40:43], s22 offen
  s_add_u32 s22, s22, 8192
  buffer_load_dword v234, v8, s[40:43], s22 offen
  s_add_u32 s22, s22, 8192
  s_mov_b64 exec, 0xff
  buffer_load_dword v234, v8, s[40:43], s22 offen
  s_add_u32 s22, s22, 8192
  s_mov_b64 exec, -1
  s_add_u32 s8, s6, 27262976
  s_addc_u32 s9, s7, 0
  s_load_dword s100, s[8:9], 0
  s_mov_b32 s36, s6
  s_and_b32 s37, s7, 0xffff
  s_mov_b32 s38, 33554432
  s_mov_b32 s39, 0x20000
  s_waitcnt lgkmcnt(0)
  s_mul_i32 s100, s100, 1664525
  s_add_u32 s100, s100, 1013904223
  s_or_b32 s100, s100, 0x100
  v_mov_b32 v220, 0x3f803f80
  v_mov_b32 v221, 0xffff0000
  v_mov_b32 v212, 0
  v_mov_b32 v213, 0
  v_mov_b32 v214, 0
  v_mov_b32 v215, 0
  s_mul_i32 s22, s13, 2688
  s_add_u32 s22, s22, 142848
  v_mul_u32_u24 v226, 1344, v6
  v_lshl_add_u32 v226, v7, 3, v226
  v_add_u32 v226, s22, v226
  v_lshlrev_b32 v227, 3, v6
  s_lshl_b32 s22, s101, 6
  s_lshl_b32 s23, s13, 4
  s_add_u32 s22, s22, s23
  s_add_u32 s22, s22, 25165824
  s_add_u32 s23, s22, 65536
  s_waitcnt vmcnt(3)
  v_dot2_f32_bf16 v212, v200, v220, v212
  v_dot2_f32_bf16 v214, v200, v200, v214
  v_dot2_f32_bf16 v213, v201, v220, v213
  v_dot2_f32_bf16 v215, v201, v201, v215
  v_dot2_f32_bf16 v212, v202, v220, v212
  v_dot2_f32_bf16 v214, v202, v202, v214
  v_dot2_f32_bf16 v213, v203, v220, v213
  v_dot2_f32_bf16 v215, v203, v203, v215
  v_dot2_f32_bf16 v212, v204, v220, v212
  v_dot2_f32_bf16 v214, v204, v204, v214
  v_dot2_f32_bf16 v213, v205, v220, v213
  v_dot2_f32_bf16 v215, v205, v205, v215
  v_dot2_f32_bf16 v212, v206, v220, v212
  v_dot2_f32_bf16 v214, v206, v206, v214
  v_dot2_f32_bf16 v213, v207, v220, v213
  v_dot2_f32_bf16 v215, v207, v207, v215
  v_dot2_f32_bf16 v212, v208, v220, v212
  v_dot2_f32_bf16 v214, v208, v208, v214
  v_dot2_f32_bf16 v213, v209, v220, v213
  v_dot2_f32_bf16 v215, v209, v209, v215
  s_nop 1
  v_add_f32 v212, v212, v213
  v_add_f32 v214, v214, v215
  s_nop 0
  v_add_f32_dpp v212, v212, v212 quad_perm:[1,0,3,2] row_mask:0xf bank_mask:0xf
  v_add_f32_dpp v214, v214, v214 quad_perm:[1,0,3,2] row_mask:0xf bank_mask:0xf
  s_nop 0
  v_add_f32_dpp v212, v212, v212 quad_perm:[2,3,0,1] row_mask:0xf bank_mask:0xf
  v_add_f32_dpp v214, v214, v214 quad_perm:[2,3,0,1] row_mask:0xf bank_mask:0xf
  s_nop 0
  v_add_f32_dpp v212, v212, v212 row_half_mirror row_mask:0xf bank_mask:0xf
  v_add_f32_dpp v214, v214, v214 row_half_mirror row_mask:0xf bank_mask:0xf
  s_nop 0
  v_add_f32_dpp v212, v212, v212 row_mirror row_mask:0xf bank_mask:0xf
  v_add_f32_dpp v214, v214, v214 row_mirror row_mask:0xf bank_mask:0xf
  v_mov_b32 v213, v212
  v_mov_b32 v215, v214
  s_nop 0
  v_permlane16_swap_b32 v212, v213
  v_permlane16_swap_b32 v214, v215
  v_add_f32 v212, v212, v213
  v_add_f32 v214, v214, v215
  v_mul_f32 v212, 0x3acccccd, v212
  v_mul_f32 v214, 0x3acccccd, v214
  v_fma_f32 v214, -v212, v212, v214
  v_max_f32 v214, 0, v214
  v_cvt_pk_bf16_f32 v214, v214, v214
  v_lshlrev_b32 v214, 16, v214
  v_add_f32 v214, 0x3727c5ac, v214
  v_cvt_pk_bf16_f32 v214, v214, v214
  v_lshlrev_b32 v214, 16, v214
  v_sqrt_f32 v214, v214
  v_mov_b32 v217, s100
  v_cvt_pk_bf16_f32 v216, v212, v214
  s_mov_b32 exec_lo, 1
  s_mov_b32 exec_hi, 1
  buffer_store_dwordx2 v[216:217], v227, s[36:39], s22 offen sc1
  s_mov_b64 exec, -1
  v_and_b32 v214, v221, v216
  v_lshlrev_b32 v212, 16, v216
  v_rcp_f32 v214, v214
  v_lshlrev_b32 v222, 16, v200
  v_lshlrev_b32 v224, 16, v201
  v_and_b32 v223, v221, v200
  v_and_b32 v225, v221, v201
  v_sub_f32 v222, v222, v212
  v_sub_f32 v224, v224, v212
  v_sub_f32 v223, v223, v212
  v_sub_f32 v225, v225, v212
  v_cvt_pk_bf16_f32 v200, v222, v223
  v_cvt_pk_bf16_f32 v201, v224, v225
  v_lshlrev_b32 v222, 16, v200
  v_lshlrev_b32 v224, 16, v201
  v_and_b32 v223, v221, v200
  v_and_b32 v225, v221, v201
  v_mul_f32 v222, v222, v214
  v_mul_f32 v224, v224, v214
  v_mul_f32 v223, v223, v214
  v_mul_f32 v225, v225, v214
  v_cvt_pk_bf16_f32 v200, v222, v223
  v_cvt_pk_bf16_f32 v201, v224, v225
  ds_write_b64 v226, v[200:201] offset:0
  v_lshlrev_b32 v222, 16, v202
  v_lshlrev_b32 v224, 16, v203
  v_and_b32 v223, v221, v202
  v_and_b32 v225, v221, v203
  v_sub_f32 v222, v222, v212
  v_sub_f32 v224, v224, v212
  v_sub_f32 v223, v223, v212
  v_sub_f32 v225, v225, v212
  v_cvt_pk_bf16_f32 v202, v222, v223
  v_cvt_pk_bf16_f32 v203, v224, v225
  v_lshlrev_b32 v222, 16, v202
  v_lshlrev_b32 v224, 16, v203
  v_and_b32 v223, v221, v202
  v_and_b32 v225, v221, v203
  v_mul_f32 v222, v222, v214
  v_mul_f32 v224, v224, v214
  v_mul_f32 v223, v223, v214
  v_mul_f32 v225, v225, v214
  v_cvt_pk_bf16_f32 v202, v222, v223
  v_cvt_pk_bf16_f32 v203, v224, v225
  ds_write_b64 v226, v[202:203] offset:256
  v_lshlrev_b32 v222, 16, v204
  v_lshlrev_b32 v224, 16, v205
  v_and_b32 v223, v221, v204
  v_and_b32 v225, v221, v205
  v_sub_f32 v222, v222, v212
  v_sub_f32 v224, v224, v212
  v_sub_f32 v223, v223, v212
  v_sub_f32 v225, v225, v212
  v_cvt_pk_bf16_f32 v204, v222, v223
  v_cvt_pk_bf16_f32 v205, v224, v225
  v_lshlrev_b32 v222, 16, v204
  v_lshlrev_b32 v224, 16, v205
  v_and_b32 v223, v221, v204
  v_and_b32 v225, v221, v205
  v_mul_f32 v222, v222, v214
  v_mul_f32 v224, v224, v214
  v_mul_f32 v223, v223, v214
  v_mul_f32 v225, v225, v214
  v_cvt_pk_bf16_f32 v204, v222, v223
  v_cvt_pk_bf16_f32 v205, v224, v225
  ds_write_b64 v226, v[204:205] offset:512
  v_lshlrev_b32 v222, 16, v206
  v_lshlrev_b32 v224, 16, v207
  v_and_b32 v223, v221, v206
  v_and_b32 v225, v221, v207
  v_sub_f32 v222, v222, v212
  v_sub_f32 v224, v224, v212
  v_sub_f32 v223, v223, v212
  v_sub_f32 v225, v225, v212
  v_cvt_pk_bf16_f32 v206, v222, v223
  v_cvt_pk_bf16_f32 v207, v224, v225
  v_lshlrev_b32 v222, 16, v206
  v_lshlrev_b32 v224, 16, v207
  v_and_b32 v223, v221, v206
  v_and_b32 v225, v221, v207
  v_mul_f32 v222, v222, v214
  v_mul_f32 v224, v224, v214
  v_mul_f32 v223, v223, v214
  v_mul_f32 v225, v225, v214
  v_cvt_pk_bf16_f32 v206, v222, v223
  v_cvt_pk_bf16_f32 v207, v224, v225
  ds_write_b64 v226, v[206:207] offset:768
  v_lshlrev_b32 v222, 16, v208
  v_lshlrev_b32 v224, 16, v209
  v_and_b32 v223, v221, v208
  v_and_b32 v225, v221, v209
  v_sub_f32 v222, v222, v212
  v_sub_f32 v224, v224, v212
  v_sub_f32 v223, v223, v212
  v_sub_f32 v225, v225, v212
  v_cvt_pk_bf16_f32 v208, v222, v223
  v_cvt_pk_bf16_f32 v209, v224, v225
  v_lshlrev_b32 v222, 16, v208
  v_lshlrev_b32 v224, 16, v209
  v_and_b32 v223, v221, v208
  v_and_b32 v225, v221, v209
  v_mul_f32 v222, v222, v214
  v_mul_f32 v224, v224, v214
  v_mul_f32 v223, v223, v214
  v_mul_f32 v225, v225, v214
  v_cvt_pk_bf16_f32 v208, v222, v223
  v_cvt_pk_bf16_f32 v209, v224, v225
  ds_write_b64 v226, v[208:209] offset:1024
  s_waitcnt lgkmcnt(0)
  s_barrier
  s_cmp_eq_u32 s14, 31
  s_cbranch_scc1 CT_E
  v_min_u32 v21, 47, v1
  v_lshlrev_b32 v21, 7, v21
  v_and_b32 v30, 7, v1
  v_lshlrev_b32 v30, 7, v30
  s_mov_b32 s59, 27264000
  s_and_b32 s20, s18, 15
  s_lshr_b32 s21, s3, 1
  s_mul_i32 s21, s21, 1769472
  s_mul_i32 s22, s78, 28672
  s_add_u32 s21, s21, s22
  v_and_b32 v23, 1, v1
  v_lshlrev_b32 v23, 2, v23
  v_add_u32 v23, 163352, v23
SG_58:
  ds_read_b32 v24, v23
  s_waitcnt lgkmcnt(0)
  v_cmp_gt_u32 vcc, 1, v24
  s_cbranch_vccz SO_59
  s_sleep 1
  s_add_u32 s79, s79, 1
  s_cmp_lt_u32 s79, 200000
  s_cbranch_scc1 SG_58
SO_59:
CT_L:
  s_lshr_b32 s22, s20, 1
  s_and_b32 s41, s22, 7
  s_lshl_b32 s41, s41, 2
  s_lshr_b32 s22, s22, 3
  s_add_u32 s41, s41, s22
  s_mul_i32 s41, s41, 55296
  s_add_u32 s41, s41, s21
  s_and_b32 s22, s20, 1
  s_mul_i32 s22, s22, 14336
  s_add_u32 s41, s41, s22
  buffer_load_dword v22, v8, s[36:39], s41 offen sc1
  s_add_u32 s41, s41, 8192
  buffer_load_dword v22, v21, s[36:39], s41 offen sc1
  s_add_u32 s41, s41, 8192
  s_waitcnt vmcnt(4)
  s_add_u32 s20, s20, 12
  s_cmp_lt_u32 s20, 40
  s_cbranch_scc1 CT_L
CT_E:
  s_lshl_b32 s22, s13, 2
  s_add_u32 s22, s22, 163336
  v_mov_b32 v250, s22
  v_mov_b32 v251, 2
  s_mov_b64 exec, 1
  ds_write_b32 v250, v251
  s_mov_b64 exec, -1
  s_branch G2
KC:
  s_waitcnt lgkmcnt(0)
  s_add_u32 s8, s6, 27262976
  s_addc_u32 s9, s7, 0
  s_load_dword s100, s[8:9], 0
  s_mov_b32 s36, s6
  s_and_b32 s37, s7, 0xffff
  s_mov_b32 s38, 33554432
  s_mov_b32 s39, 0x20000
  s_waitcnt lgkmcnt(0)
  s_mul_i32 s100, s100, 1664525
  s_add_u32 s100, s100, 1013904223
  s_or_b32 s100, s100, 0x100
  s_getreg_b32 s23, hwreg(HW_REG_XCC_ID, 0, 4)
  s_add_u32 s23, s23, 1
  s_xor_b32 s23, s23, s100
  s_lshl_b32 s22, s101, 2
  s_add_u32 s22, s22, 27266048
  s_cmp_eq_u32 s12, 5
  s_cselect_b32 s22, s22, 0x7f000000
  v_mov_b32 v2, s23
  v_mov_b32 v3, 0
  s_mov_b64 exec, 1
  buffer_store_dword v2, v3, s[36:39], s22 offen
  s_mov_b64 exec, -1
  v_bfe_u32 v4, v1, 2, 2
  v_mul_u32_u24 v5, 1344, v4
  v_lshrrev_b32 v4, 4, v1
  v_lshl_add_u32 v5, v4, 5, v5
  v_and_b32 v4, 3, v1
  v_lshl_add_u32 v5, v4, 3, v5
  s_mul_i32 s22, s13, 640
  s_add_u32 s22, s22, 142848
  v_add_u32 v5, s22, v5
  v_lshlrev_b32 v6, 4, v1
  v_add_u32 v7, 4096, v6
  s_mul_i32 s43, s101, 10240
  s_mul_i32 s22, s13, 5120
  s_add_u32 s43, s43, s22
  s_add_u32 s43, s43, 12582912
  s_cmp_lt_u32 s13, 2
  s_cselect_b32 s43, s43, 0x7f000000
  s_barrier
  s_cmp_eq_u32 s12, 6
  s_cbranch_scc1 KC_A
  ds_read_b64_tr_b16 v[8:9], v5 offset:0
  ds_read_b64_tr_b16 v[10:11], v5 offset:5376
  ds_read_b64_tr_b16 v[12:13], v5 offset:128
  ds_read_b64_tr_b16 v[14:15], v5 offset:5504
  ds_read_b64_tr_b16 v[16:17], v5 offset:256
  ds_read_b64_tr_b16 v[18:19], v5 offset:5632
  ds_read_b64_tr_b16 v[20:21], v5 offset:384
  ds_read_b64_tr_b16 v[22:23], v5 offset:5760
  ds_read_b64_tr_b16 v[24:25], v5 offset:512
  ds_read_b64_tr_b16 v[26:27], v5 offset:5888
  s_waitcnt lgkmcnt(0)
  buffer_store_dwordx4 v[8:11], v6, s[36:39], s43 offen offset:0 sc1
  buffer_store_dwordx4 v[12:15], v6, s[36:39], s43 offen offset:1024 sc1
  buffer_store_dwordx4 v[16:19], v6, s[36:39], s43 offen offset:2048 sc1
  buffer_store_dwordx4 v[20:23], v6, s[36:39], s43 offen offset:3072 sc1
  buffer_store_dwordx4 v[24:27], v7, s[36:39], s43 offen offset:0 sc1
  s_lshl_b32 s22, s3, 7
  s_add_u32 s22, s22, 27272192
  s_lshl_b32 s23, s14, 3
  s_add_u32 s23, s23, s12
  s_cmp_eq_u32 s23, 228
  s_cselect_b32 s22, s22, 0x7f000000
  v_mov_b32 v30, 0
  v_mov_b32 v31, 0
  s_mov_b64 exec, 1
  buffer_store_dword v30, v31, s[36:39], s22 offen sc1
  s_mov_b64 exec, -1
  s_lshl_b32 s21, s14, 1
  s_add_u32 s21, s21, s13
  s_lshl_b32 s22, s3, 10
  s_lshl_b32 s23, s21, 2
  s_add_u32 s22, s22, s23
  s_add_u32 s22, s22, 27279360
  s_add_u32 s23, s22, 8192
  v_mov_b32 v2, s100
  v_mov_b32 v3, 0
  s_mov_b64 exec, 1
  s_waitcnt vmcnt(0)
  buffer_store_dword v2, v3, s[36:39], s22 offen
  buffer_store_dword v2, v3, s[36:39], s23 offen sc1
  s_mov_b64 exec, -1
  s_lshl_b32 s22, s13, 2
  s_add_u32 s22, s22, 163352
  v_mov_b32 v2, s22
  v_mov_b32 v3, 1
  ds_write_b32 v2, v3
  s_cmp_eq_u32 s12, 4
  s_cbranch_scc1 M_END
KC_A:
  s_cmp_eq_u32 s12, 5
  s_cbranch_scc1 KC_B
  v_min_u32 v13, 27, v1
  s_and_b32 s22, s3, 1
  v_subrev_u32 v14, s22, v13
  v_cmp_eq_u32 vcc, 13, v13
  v_cmp_eq_u32 s[62:63], 27, v13
  s_nop 2
  s_or_b64 vcc, vcc, s[62:63]
  v_cndmask_b32 v13, v13, v14, vcc
  v_lshlrev_b32 v13, 2, v13
  s_lshl_b32 s59, s15, 1
  s_add_u32 s59, s59, s22
  s_lshl_b32 s59, s59, 2
  s_add_u32 s59, s59, 3
  s_lshl_b32 s59, s59, 7
  s_add_u32 s59, s59, 27312128
  v_and_b32 v16, 7, v1
  v_lshlrev_b32 v16, 7, v16
  s_lshl_b32 s60, s15, 10
  s_add_u32 s60, s60, 25165824
KC_R:
  s_sleep 40
  s_getpc_b64 s[10:11]
PC_60:
  s_sub_u32 s10, s10, PC_60-KSTART
  s_subb_u32 s11, s11, 0
  v_lshlrev_b32 v55, 7, v1
  s_and_b32 s22, s14, 3
  s_lshl_b32 s22, s22, 14
  v_add_u32 v55, s22, v55
  v_min_u32 v52, M_END-KSTART, v55
  v_mov_b32 v53, s11
  v_add_co_u32 v52, vcc, s10, v52
  s_nop 1
  v_addc_co_u32 v53, vcc, 0, v53, vcc
  global_load_dword v56, v[52:53], off sc1
  v_add_u32 v55, 8192, v55
  v_min_u32 v52, M_END-KSTART, v55
  v_mov_b32 v53, s11
  v_add_co_u32 v52, vcc, s10, v52
  s_nop 1
  v_addc_co_u32 v53, vcc, 0, v53, vcc
  global_load_dword v56, v[52:53], off sc1
  v_add_u32 v55, 8192, v55
  buffer_load_dword v17, v16, s[36:39], s60 offen sc1
  buffer_load_dword v15, v13, s[36:39], s59 offen sc1
  s_waitcnt vmcnt(0)
  v_cmp_ne_u32 vcc, s100, v15
  s_cbranch_vccz CT_61
  s_add_u32 s79, s79, 1
  s_cmp_lt_u32 s79, 20000
  s_cbranch_scc1 KC_R
CT_61:
  s_endpgm
KC_B:
  s_cmp_lg_u32 s14, 31
  s_cbranch_scc1 LD_N1
  v_min_u32 v34, 15, v1
  v_lshlrev_b32 v34, 4, v34
  s_lshl_b32 s20, s3, 10
  s_add_u32 s20, s20, 27279360
  s_mov_b32 s21, 0
LD_62:
  s_sleep 2
  s_add_u32 s21, s21, 1
  s_and_b32 s22, s21, 31
  s_cmp_eq_u32 s22, 0
  s_cselect_b32 s22, 8192, 0
  s_add_u32 s22, s22, s20
  buffer_load_dwordx4 v[36:39], v34, s[36:39], s22 offen sc1
  s_waitcnt vmcnt(0)
  v_cmp_ne_u32 vcc, s100, v36
  v_cmp_ne_u32 s[62:63], s100, v37
  s_nop 2
  s_or_b64 vcc, vcc, s[62:63]
  v_cmp_ne_u32 s[62:63], s100, v38
  s_nop 2
  s_or_b64 vcc, vcc, s[62:63]
  v_cmp_ne_u32 s[62:63], s100, v39
  s_nop 2
  s_or_b64 vcc, vcc, s[62:63]
  s_cbranch_vccz CT_63
  s_add_u32 s79, s79, 1
  s_cmp_lt_u32 s79, 20000
  s_cbranch_scc1 LD_62
CT_63:
  s_lshl_b32 s22, s3, 7
  s_add_u32 s22, s22, 27264000
  v_mov_b32 v34, s100
  v_mov_b32 v35, 0
  s_mov_b64 exec, 1
  buffer_store_dword v34, v35, s[36:39], s22 offen sc1
  s_mov_b64 exec, -1
LD_N1:
  s_cmp_lg_u32 s14, 30
  s_cbranch_scc1 LD_N3
  v_min_u32 v34, 19, v1
  v_lshlrev_b32 v34, 4, v34
  s_lshl_b32 s20, s3, 10
  s_add_u32 s20, s20, 27279744
  s_mov_b32 s21, 0
LD_64:
  s_sleep 4
  s_add_u32 s21, s21, 1
  s_and_b32 s22, s21, 31
  s_cmp_eq_u32 s22, 0
  s_cselect_b32 s22, 8192, 0
  s_add_u32 s22, s22, s20
  buffer_load_dwordx4 v[36:39], v34, s[36:39], s22 offen sc1
  s_waitcnt vmcnt(0)
  v_cmp_ne_u32 vcc, s100, v36
  v_cmp_ne_u32 s[62:63], s100, v37
  s_nop 2
  s_or_b64 vcc, vcc, s[62:63]
  v_cmp_ne_u32 s[62:63], s100, v38
  s_nop 2
  s_or_b64 vcc, vcc, s[62:63]
  v_cmp_ne_u32 s[62:63], s100, v39
  s_nop 2
  s_or_b64 vcc, vcc, s[62:63]
  s_cbranch_vccz CT_65
  s_add_u32 s79, s79, 1
  s_cmp_lt_u32 s79, 20000
  s_cbranch_scc1 LD_64
CT_65:
  s_lshl_b32 s22, s3, 7
  s_add_u32 s22, s22, 27271168
  v_mov_b32 v34, s100
  v_mov_b32 v35, 0
  s_mov_b64 exec, 1
  buffer_store_dword v34, v35, s[36:39], s22 offen sc1
  s_mov_b64 exec, -1
LD_N3:
  s_endpgm
M_END:
  s_endpgm
.section .rodata,"a"
.p2align 6
.amdhsa_kernel parallel_sum__ssm_conv_s4__dense_activation_gelu__prompt_kernel
  .amdhsa_next_free_vgpr 256
  .amdhsa_next_free_sgpr 102
  .amdhsa_accum_offset 256
  .amdhsa_group_segment_fixed_size 0
  .amdhsa_kernarg_size 136
  .amdhsa_user_sgpr_count 2
  .amdhsa_user_sgpr_kernarg_segment_ptr 1
  .amdhsa_system_sgpr_workgroup_id_x 1
.end_amdhsa_kernel
```
